```python
import torch

def _softmax(x, axis=-1):
    return torch.softmax(x, dim=axis)
def _gelu(x):
    return torch.nn.functional.gelu(x, approximate="tanh")
def _silu(x):
    return torch.nn.functional.silu(x)
def _sigmoid(x):
    return torch.sigmoid(x)
def _layernorm(x, axis=-1, eps=1e-5):
    m = x.mean(dim=axis, keepdim=True)
    v = x.var(dim=axis, keepdim=True, unbiased=False)
    return (x - m) / torch.sqrt(v + eps)
def _scatter_add(tgt, idx, src, axis=0):
    return tgt.clone().index_add_(axis, idx, src)
def _segment_sum(src, seg, n):
    out = torch.zeros((n,) + src.shape[1:], dtype=src.dtype)
    return out.index_add_(0, seg, src)
def _pad(x, pw):
    flat = tuple(v for pair in reversed(pw) for v in pair)
    return torch.nn.functional.pad(x, flat)

kernel_name = 'gated_mix__ssm_conv_s5__glu_gated_geglu__prompt'

def setup_inputs():

    _w = (lambda a: (lambda t: t.to(torch.bfloat16) if t.is_floating_point() else t)(torch.as_tensor(a)))
    def _A_setup():
        B, S, D = 1, 2048, 448
        P = D
        Lambda_re = -0.5 * (lambda _x: torch.exp(torch.as_tensor(_x)))((lambda *s: torch.randn(*s, dtype=torch.bfloat16) * 0.4)(P))
        Lambda_im = (lambda *s: torch.randn(*s, dtype=torch.bfloat16) * 0.8)(P) * 1.0
        B_re = (lambda *s: torch.randn(*s, dtype=torch.bfloat16) * 0.8)(P, D) * (D ** -0.5)
        B_im = (lambda *s: torch.randn(*s, dtype=torch.bfloat16) * 0.8)(P, D) * (D ** -0.5)
        C_re = (lambda *s: torch.randn(*s, dtype=torch.bfloat16) * 0.8)(D, P) * (P ** -0.5)
        C_im = (lambda *s: torch.randn(*s, dtype=torch.bfloat16) * 0.8)(D, P) * (P ** -0.5)
        log_dt = (lambda *s: torch.randn(*s, dtype=torch.bfloat16) * 0.4)(P) * 0.3 - 2.0
        Dskip = (lambda *s: torch.randn(*s, dtype=torch.bfloat16) * 0.1)(D)
        return {
            "x": _w((lambda *s: torch.randn(*s, dtype=torch.bfloat16) * 0.05)(B, S, D)),
            "Lambda_re": _w(Lambda_re),
            "Lambda_im": _w(Lambda_im),
            "B_re": _w(B_re),
            "B_im": _w(B_im),
            "C_re": _w(C_re),
            "C_im": _w(C_im),
            "log_dt": _w(log_dt),
            "Dskip": _w(Dskip),
        }
    _A_in = _A_setup()

    def _B_setup():
        B, S, Dm, Df = 1, 2048, 448, 1792
        return {
            "x": _w((lambda *s: torch.randn(*s, dtype=torch.bfloat16) * 0.05)(B, S, Dm)),
            "w_gate": _w((lambda *s: torch.randn(*s, dtype=torch.bfloat16) * 3.2)(Dm, Df) * (Dm ** -0.5)),
            "w_up": _w((lambda *s: torch.randn(*s, dtype=torch.bfloat16) * 3.2)(Dm, Df) * (Dm ** -0.5)),
            "w_down": _w((lambda *s: torch.randn(*s, dtype=torch.bfloat16) * 3.2)(Df, Dm) * (Df ** -0.5)),
        }
    _B_in = _B_setup()

    return {
        "A_x": _A_in["x"],
        "A_Lambda_re": _A_in["Lambda_re"],
        "A_Lambda_im": _A_in["Lambda_im"],
        "A_B_re": _A_in["B_re"],
        "A_B_im": _A_in["B_im"],
        "A_C_re": _A_in["C_re"],
        "A_C_im": _A_in["C_im"],
        "A_log_dt": _A_in["log_dt"],
        "A_Dskip": _A_in["Dskip"],
        "B_x": _B_in["x"],
        "B_w_gate": _B_in["w_gate"],
        "B_w_up": _B_in["w_up"],
        "B_w_down": _B_in["w_down"],
        "gate_w": _w((lambda *s: torch.randn(*s, dtype=torch.bfloat16) * 0.05)(448) * 16.0),
    }

def reference(A_x, A_Lambda_re, A_Lambda_im, A_B_re, A_B_im, A_C_re, A_C_im, A_log_dt, A_Dskip, B_x, B_w_gate, B_w_up, B_w_down, gate_w):
    def _A_ref(x, Lambda_re, Lambda_im, B_re, B_im, C_re, C_im, log_dt, Dskip):
        Bsz, L, H = x.shape
        Lam = Lambda_re + 1j * Lambda_im
        Bmat = B_re + 1j * B_im
        Cmat = C_re + 1j * C_im
        dt = torch.exp(log_dt)
        Lam_bar = torch.exp(dt * Lam)
        B_bar = ((Lam_bar - 1.0) / Lam)[:, None] * Bmat
        Bu = torch.einsum("bld,pd->blp", x + 0j, B_bar)
        h = torch.zeros_like(Bu[:, 0, :])
        hs = []
        for t in range(L):
            h = Lam_bar[None, :] * h + Bu[:, t, :]
            hs.append(h)
        hseq = torch.stack(hs, 1)
        y = 2.0 * torch.einsum("blp,dp->bld", hseq, Cmat).real + x * Dskip[None, None, :]
        return y

    def _B_ref(x, w_gate, w_up, w_down):
        g = torch.einsum("bsd,df->bsf", x, w_gate)
        u = torch.einsum("bsd,df->bsf", x, w_up)
        h = _gelu(g) * u
        return torch.einsum("bsf,fd->bsd", h, w_down)

    x = A_x
    g = _sigmoid((x * gate_w).sum(-1, keepdims=True))
    a = _A_ref(x, A_Lambda_re, A_Lambda_im, A_B_re, A_B_im, A_C_re, A_C_im, A_log_dt, A_Dskip)
    b = _B_ref(x, B_w_gate, B_w_up, B_w_down)
    return g * a + (1 - g) * b
```

```asm
; @launch grid=(256,1,1) block=(256,1,1) lds=163840
.amdgcn_target "amdgcn-amd-amdhsa--gfx950"
.text
.globl gated_mix__ssm_conv_s5__glu_gated_geglu__prompt_kernel
.p2align 8
.type gated_mix__ssm_conv_s5__glu_gated_geglu__prompt_kernel,@function
gated_mix__ssm_conv_s5__glu_gated_geglu__prompt_kernel:
  s_cmp_ge_u32 s2, 256
  s_cbranch_scc1 L1_end
  s_load_dwordx16 s[48:63], s[0:1], 0
  s_load_dwordx16 s[64:79], s[0:1], 64
  s_load_dwordx2 s[80:81], s[0:1], 128
  s_and_b32 s3, s2, 7
  s_lshr_b32 s46, s2, 3
  s_cmp_ge_u32 s46, 28
  s_cbranch_scc1 L1_prep
  s_mul_i32 s47, s46, 37
  s_lshr_b32 s47, s47, 8
  s_and_b32 s38, s3, 3
  s_lshl_b32 s38, s38, 2
  s_add_u32 s38, s38, s47
  s_mul_i32 s47, s47, 7
  s_sub_u32 s46, s46, s47
  s_lshr_b32 s39, s3, 2
  s_mul_i32 s39, s39, 7
  s_add_u32 s39, s39, s46
  v_lshrrev_b32 v60, 6, v0
  v_and_b32 v0, 63, v0
  v_readfirstlane_b32 s40, v60
  s_nop 0
  s_lshl_b32 s36, s40, 12
  s_and_b32 s41, s40, 1
  s_lshr_b32 s42, s40, 1
  v_lshrrev_b32 v61, 3, v0
  v_and_b32 v62, 7, v0
  v_lshrrev_b32 v63, 4, v0
  v_xor_b32 v58, v62, v63
  v_lshlrev_b32 v58, 4, v58
  v_lshrrev_b32 v59, 5, v0
  v_and_b32 v60, 3, v61
  v_lshl_add_u32 v59, v59, 4, v60
  s_lshl_b32 s46, s38, 7
  s_lshl_b32 s47, s40, 5
  s_add_u32 s46, s46, s47
  v_add_u32 v59, s46, v59
  s_movk_i32 s47, 896
  v_mad_u32_u24 v1, v59, s47, v58
  v_xor_b32 v2, 64, v58
  v_mad_u32_u24 v2, v59, s47, v2
  v_add_u32 v2, 2560, v2
  v_add_u32 v3, 5120, v1
  v_add_u32 v4, 5120, v2
  s_lshl_b32 s46, s39, 5
  v_add_u32 v59, s46, v61
  v_mad_u32_u24 v9, v59, s47, v58
  v_xor_b32 v10, 64, v58
  v_mad_u32_u24 v10, v59, s47, v10
  v_add_u32 v10, 6144, v10
  v_add_u32 v11, 12288, v9
  v_add_u32 v12, 12288, v10
  s_mul_i32 s84, s38, 2
  s_mul_i32 s85, s39, 1
  s_add_u32 s84, s84, s85
  s_mul_i32 s85, s84, 37
  s_lshr_b32 s85, s85, 8
  s_mul_i32 s85, s85, 7
  s_sub_u32 s87, s84, s85
  s_add_u32 s90, s87, 1
  s_cmp_eq_u32 s90, 7
  s_cselect_b32 s90, 0, s90
  s_add_u32 s91, s90, 1
  s_cmp_eq_u32 s91, 7
  s_cselect_b32 s91, 0, s91
  s_add_u32 s92, s91, 1
  s_cmp_eq_u32 s92, 7
  s_cselect_b32 s92, 0, s92
  s_add_u32 s93, s92, 1
  s_cmp_eq_u32 s93, 7
  s_cselect_b32 s93, 0, s93
  s_add_u32 s100, s93, 1
  s_cmp_eq_u32 s100, 7
  s_cselect_b32 s100, 0, s100
  s_add_u32 s101, s100, 1
  s_cmp_eq_u32 s101, 7
  s_cselect_b32 s101, 0, s101
  s_waitcnt lgkmcnt(0)
  s_mov_b32 s4, s48
  s_mov_b32 s5, s49
  s_mov_b32 s6, 1835008
  s_mov_b32 s7, 0x00020000
  s_cmp_eq_u32 s41, 0
  s_cselect_b32 s16, s54, s56
  s_cselect_b32 s17, s55, s57
  s_mov_b32 s18, 401408
  s_mov_b32 s19, 0x00020000
  s_add_u32 m0, s36, 0
  s_lshl_b32 s37, s87, 7
  buffer_load_dwordx4 v1, s[4:7], s37 offen offset:0 lds
  buffer_load_dwordx4 v2, s[4:7], s37 offen offset:1024 lds
  buffer_load_dwordx4 v3, s[4:7], s37 offen offset:2048 lds
  buffer_load_dwordx4 v4, s[4:7], s37 offen offset:3072 lds
  s_add_u32 m0, s36, 16384
  s_cmp_eq_u32 s42, 0
  s_cselect_b32 s37, s87, s90
  s_lshl_b32 s37, s37, 7
  buffer_load_dwordx4 v9, s[16:19], s37 offen offset:0 lds
  buffer_load_dwordx4 v10, s[16:19], s37 offen offset:1024 lds
  buffer_load_dwordx4 v11, s[16:19], s37 offen offset:2048 lds
  buffer_load_dwordx4 v12, s[16:19], s37 offen offset:3072 lds
  v_and_b32 v57, 31, v0
  v_add_u32 v59, s46, v57
  v_lshlrev_b32 v59, 1, v59
  s_mov_b32 s32, s50
  s_mov_b32 s33, s51
  s_mov_b32 s34, 896
  s_mov_b32 s35, 0x00020000
  buffer_load_ushort v54, v59, s[32:35], 0 offen
  s_mov_b32 s32, s52
  s_mov_b32 s33, s53
  s_mov_b32 s34, 896
  s_mov_b32 s35, 0x00020000
  buffer_load_ushort v55, v59, s[32:35], 0 offen
  s_mov_b32 s32, s62
  s_mov_b32 s33, s63
  s_mov_b32 s34, 896
  s_mov_b32 s35, 0x00020000
  buffer_load_ushort v56, v59, s[32:35], 0 offen
  s_add_u32 m0, s36, 32768
  s_lshl_b32 s37, s90, 7
  buffer_load_dwordx4 v1, s[4:7], s37 offen offset:0 lds
  buffer_load_dwordx4 v2, s[4:7], s37 offen offset:1024 lds
  buffer_load_dwordx4 v3, s[4:7], s37 offen offset:2048 lds
  buffer_load_dwordx4 v4, s[4:7], s37 offen offset:3072 lds
  s_add_u32 m0, s36, 49152
  s_lshl_b32 s37, s91, 7
  buffer_load_dwordx4 v1, s[4:7], s37 offen offset:0 lds
  buffer_load_dwordx4 v2, s[4:7], s37 offen offset:1024 lds
  buffer_load_dwordx4 v3, s[4:7], s37 offen offset:2048 lds
  buffer_load_dwordx4 v4, s[4:7], s37 offen offset:3072 lds
  v_and_b32 v59, 1, v63
  v_lshlrev_b32 v59, 1, v59
  v_xor_b32 v59, v59, v62
  v_lshlrev_b32 v59, 4, v59
  s_lshl_b32 s46, s39, 8
  v_add_u32 v59, s46, v59
  s_lshl_b32 s46, s40, 4
  v_add_u32 v60, s46, v61
  s_movk_i32 s47, 3584
  v_mad_u32_u24 v5, v60, s47, v59
  v_add_u32 v6, 27648, v5
  v_xor_b32 v7, 64, v5
  v_xor_b32 v8, 64, v6
  s_mov_b32 s8, s68
  s_mov_b32 s9, s69
  s_mov_b32 s10, 1605632
  s_mov_b32 s11, 0x00020000
  s_sub_u32 s12, s70, 2048
  s_subb_u32 s13, s71, 0
  s_mov_b32 s14, 1607680
  s_mov_b32 s15, 0x00020000
  s_cmp_eq_u32 s42, 0
  s_movk_i32 s82, 768
  s_cselect_b32 s82, s82, 2147483632
  s_mov_b32 s20, s80
  s_mov_b32 s21, s81
  s_mov_b32 s22, 13500416
  s_mov_b32 s23, 0x00020000
  s_mov_b32 s28, s78
  s_mov_b32 s29, s79
  s_mov_b32 s30, 256
  s_mov_b32 s31, 0x00020000
  s_lshl_b32 s46, s39, 12
  s_add_u32 s46, s46, 13434880
  s_add_u32 s24, s80, s46
  s_addc_u32 s25, s81, 0
  s_movk_i32 s26, 4096
  s_mov_b32 s27, 0x00020000
  v_lshrrev_b32 v60, 5, v0
  v_bfe_u32 v59, v0, 1, 3
  v_xor_b32 v59, v59, v60
  v_lshlrev_b32 v59, 4, v59
  v_lshl_add_u32 v59, v57, 7, v59
  s_lshl_b32 s46, s41, 1
  s_add_u32 s83, s46, s42
  s_lshl_b32 s46, s83, 12
  v_add_u32 v13, s46, v59
  v_xor_b32 v246, 0, v59
  v_xor_b32 v247, 32, v59
  v_xor_b32 v248, 64, v59
  v_xor_b32 v249, 96, v59
  v_xor_b32 v14, 32, v13
  v_xor_b32 v15, 64, v13
  v_xor_b32 v16, 96, v13
  v_xor_b32 v17, 4096, v13
  v_xor_b32 v18, 4096, v14
  v_xor_b32 v19, 4096, v15
  v_xor_b32 v20, 4096, v16
  v_bfe_u32 v59, v0, 4, 1
  v_bfe_u32 v61, v0, 2, 2
  v_lshrrev_b32 v62, 1, v61
  v_lshl_add_u32 v62, v59, 1, v62
  s_lshl_b32 s46, s42, 1
  v_xor_b32 v62, s46, v62
  v_lshlrev_b32 v62, 5, v62
  v_lshl_add_u32 v62, v59, 11, v62
  v_lshl_add_u32 v61, v60, 3, v61
  v_lshl_add_u32 v62, v61, 7, v62
  v_and_b32 v61, 3, v0
  v_lshl_add_u32 v21, v61, 3, v62
  v_xor_b32 v22, 32, v21
  v_lshlrev_b32 v59, 3, v0
  s_lshl_b32 s46, s40, 9
  s_add_u32 s46, s46, 147456
  v_add_u32 v59, s46, v59
  v_mov_b32 v62, 0
  v_mov_b32 v63, 0
  ds_write_b64 v59, v[62:63]
  s_waitcnt vmcnt(11) lgkmcnt(0)
  s_barrier
  ds_read_b128 a[0:3], v13 offset:0
  ds_read_b128 v[160:163], v246 offset:16384
  ds_read_b128 v[164:167], v246 offset:20480
  ds_read_b128 a[112:115], v17 offset:0
  ds_read_b128 a[4:7], v14 offset:0
  ds_read_b128 v[168:171], v247 offset:16384
  ds_read_b128 v[172:175], v247 offset:20480
  ds_read_b128 a[116:119], v18 offset:0
  s_waitcnt lgkmcnt(6)
  v_mfma_f32_32x32x16_bf16 v[128:143], a[0:3], v[160:163], 0
  ds_read_b128 a[8:11], v15 offset:0
  ds_read_b128 v[176:179], v248 offset:16384
  s_add_u32 m0, s36, 65536
  s_cmp_eq_u32 s42, 0
  s_cselect_b32 s37, s91, s92
  s_lshl_b32 s37, s37, 7
  buffer_load_dwordx4 v9, s[16:19], s37 offen offset:0 lds
  s_waitcnt lgkmcnt(7)
  v_mfma_f32_32x32x16_bf16 v[144:159], a[0:3], v[164:167], 0
  ds_read_b128 v[180:183], v248 offset:20480
  ds_read_b128 a[120:123], v19 offset:0
  buffer_load_dwordx4 v10, s[16:19], s37 offen offset:1024 lds
  s_waitcnt lgkmcnt(6)
  v_mfma_f32_32x32x16_bf16 v[128:143], a[4:7], v[168:171], v[128:143]
  ds_read_b128 a[12:15], v16 offset:0
  ds_read_b128 v[184:187], v249 offset:16384
  buffer_load_dwordx4 v11, s[16:19], s37 offen offset:2048 lds
  s_mov_b32 s44, 0xbdd2d3e8
  s_mov_b32 s45, s44
  v_mov_b32 v25, 0xc0135761
  s_waitcnt lgkmcnt(7)
  v_mfma_f32_32x32x16_bf16 v[144:159], a[4:7], v[172:175], v[144:159]
  ds_read_b128 v[188:191], v249 offset:20480
  ds_read_b128 a[124:127], v20 offset:0
  buffer_load_dwordx4 v12, s[16:19], s37 offen offset:3072 lds
  s_lshl_b32 s46, s38, 2
  s_add_u32 s46, s46, s83
  s_mul_i32 s47, s46, 172032
  s_waitcnt vmcnt(8) lgkmcnt(0)
  s_barrier
  v_mfma_f32_32x32x16_bf16 v[128:143], a[8:11], v[176:179], v[128:143]
  ds_read_b128 a[16:19], v13 offset:32768
  ds_read_b128 v[160:163], v246 offset:24576
  s_add_u32 m0, s36, 81920
  s_lshl_b32 s37, s92, 7
  buffer_load_dwordx4 v1, s[4:7], s37 offen offset:0 lds
  s_xor_b32 s46, s46, 1
  v_mfma_f32_32x32x16_bf16 v[144:159], a[8:11], v[180:183], v[144:159]
  ds_read_b128 v[164:167], v246 offset:28672
  ds_read_b128 a[128:131], v17 offset:32768
  buffer_load_dwordx4 v2, s[4:7], s37 offen offset:1024 lds
  s_mul_i32 s46, s46, 172032
  s_lshl_b32 s84, s39, 13
  s_lshl_b32 s85, s42, 11
  v_mfma_f32_32x32x16_bf16 v[128:143], a[12:15], v[184:187], v[128:143]
  ds_read_b128 a[20:23], v14 offset:32768
  ds_read_b128 v[168:171], v247 offset:24576
  buffer_load_dwordx4 v3, s[4:7], s37 offen offset:2048 lds
  s_add_u32 s84, s84, s85
  v_lshl_add_u32 v59, v0, 4, s84
  v_add_u32 v23, s47, v59
  v_mfma_f32_32x32x16_bf16 v[144:159], a[12:15], v[188:191], v[144:159]
  ds_read_b128 v[172:175], v247 offset:28672
  ds_read_b128 a[132:135], v18 offset:32768
  buffer_load_dwordx4 v4, s[4:7], s37 offen offset:3072 lds
  v_add_u32 v24, s46, v59
  s_lshl_b32 s85, s39, 12
  s_add_u32 s85, s85, 114688
  s_waitcnt lgkmcnt(6)
  v_mfma_f32_32x32x16_bf16 v[128:143], a[16:19], v[160:163], v[128:143]
  ds_read_b128 a[24:27], v15 offset:32768
  ds_read_b128 v[176:179], v248 offset:24576
  s_add_u32 m0, s36, 98304
  s_lshl_b32 s37, s93, 7
  buffer_load_dwordx4 v1, s[4:7], s37 offen offset:0 lds
  s_sub_u32 s85, s85, s84
  s_waitcnt lgkmcnt(7)
  v_mfma_f32_32x32x16_bf16 v[144:159], a[16:19], v[164:167], v[144:159]
  ds_read_b128 v[180:183], v248 offset:28672
  ds_read_b128 a[136:139], v19 offset:32768
  buffer_load_dwordx4 v2, s[4:7], s37 offen offset:1024 lds
  s_movk_i32 s86, 4096
  s_lshl_b32 s46, s83, 9
  s_add_u32 s46, s46, 147456
  s_waitcnt lgkmcnt(6)
  v_mfma_f32_32x32x16_bf16 v[128:143], a[20:23], v[168:171], v[128:143]
  ds_read_b128 a[28:31], v16 offset:32768
  ds_read_b128 v[184:187], v249 offset:24576
  buffer_load_dwordx4 v3, s[4:7], s37 offen offset:2048 lds
  v_lshl_add_u32 v59, v60, 5, v57
  v_lshl_add_u32 v26, v59, 3, s46
  s_lshl_b32 s46, s40, 13
  s_waitcnt lgkmcnt(7)
  v_mfma_f32_32x32x16_bf16 v[144:159], a[20:23], v[172:175], v[144:159]
  ds_read_b128 v[188:191], v249 offset:28672
  ds_read_b128 a[140:143], v20 offset:32768
  buffer_load_dwordx4 v4, s[4:7], s37 offen offset:3072 lds
  s_add_u32 s46, s46, 114688
  s_movk_i32 s47, 576
  v_lshl_add_u32 v59, v57, 2, s46
  s_waitcnt vmcnt(8) lgkmcnt(0)
  s_barrier
  v_mfma_f32_32x32x16_bf16 v[128:143], a[24:27], v[176:179], v[128:143]
  v_add_u32 v246, 0x10000, v246
  v_add_u32 v247, 0x10000, v247
  v_add_u32 v248, 0x10000, v248
  v_add_u32 v249, 0x10000, v249
  ds_read_b128 a[32:35], v13 offset:49152
  ds_read_b128 v[160:163], v246 offset:0
  s_add_u32 m0, s36, 114688
  s_cmp_eq_u32 s42, 0
  s_cselect_b32 s37, s93, s100
  s_lshl_b32 s37, s37, 7
  buffer_load_dwordx4 v9, s[16:19], s37 offen offset:0 lds
  v_mfma_f32_32x32x16_bf16 v[144:159], a[24:27], v[180:183], v[144:159]
  ds_read_b128 v[164:167], v246 offset:4096
  ds_read_b128 a[144:147], v17 offset:49152
  buffer_load_dwordx4 v10, s[16:19], s37 offen offset:1024 lds
  v_mad_u32_u24 v27, v60, s47, v59
  s_movk_i32 s47, 144
  v_lshl_add_u32 v59, v60, 4, s46
  v_mfma_f32_32x32x16_bf16 v[128:143], a[28:31], v[184:187], v[128:143]
  ds_read_b128 a[36:39], v14 offset:49152
  ds_read_b128 v[168:171], v247 offset:0
  buffer_load_dwordx4 v11, s[16:19], s37 offen offset:2048 lds
  v_mad_u32_u24 v28, v57, s47, v59
  s_sub_u32 s46, 15, s38
  s_lshl_b32 s46, s46, 8
  v_mfma_f32_32x32x16_bf16 v[144:159], a[28:31], v[188:191], v[144:159]
  ds_read_b128 v[172:175], v247 offset:4096
  ds_read_b128 a[148:151], v18 offset:49152
  buffer_load_dwordx4 v12, s[16:19], s37 offen offset:3072 lds
  v_lshl_add_u32 v59, v57, 3, s46
  v_add_u32 v31, 256, v59
  s_cmp_eq_u32 s83, 3
  s_cselect_b32 s47, 32, 64
  v_cmp_le_u32 vcc, s47, v0
  s_waitcnt lgkmcnt(6)
  v_mfma_f32_32x32x16_bf16 v[128:143], a[32:35], v[160:163], v[128:143]
  ds_read_b128 a[40:43], v15 offset:49152
  ds_read_b128 v[176:179], v248 offset:0
  s_add_u32 m0, s36, 131072
  s_lshl_b32 s37, s100, 7
  buffer_load_dwordx4 v1, s[4:7], s37 offen offset:0 lds
  v_mov_b32 v61, 2147483632
  s_waitcnt lgkmcnt(7)
  v_mfma_f32_32x32x16_bf16 v[144:159], a[32:35], v[164:167], v[144:159]
  ds_read_b128 v[180:183], v248 offset:4096
  ds_read_b128 a[152:155], v19 offset:49152
  buffer_load_dwordx4 v2, s[4:7], s37 offen offset:1024 lds
  s_lshl_b32 s46, s39, 7
  v_cndmask_b32 v29, v61, v59, vcc
  s_add_u32 s46, s46, 13492224
  s_waitcnt lgkmcnt(6)
  v_mfma_f32_32x32x16_bf16 v[128:143], a[36:39], v[168:171], v[128:143]
  ds_read_b128 a[44:47], v16 offset:49152
  ds_read_b128 v[184:187], v249 offset:0
  buffer_load_dwordx4 v3, s[4:7], s37 offen offset:2048 lds
  v_cmp_eq_u32 vcc, s47, v0
  s_lshl_b32 s47, s38, 2
  s_add_u32 s47, s46, s47
  s_waitcnt lgkmcnt(7)
  v_mfma_f32_32x32x16_bf16 v[144:159], a[36:39], v[172:175], v[144:159]
  ds_read_b128 v[188:191], v249 offset:4096
  ds_read_b128 a[156:159], v20 offset:49152
  buffer_load_dwordx4 v4, s[4:7], s37 offen offset:3072 lds
  v_mov_b32 v59, s47
  v_cndmask_b32 v30, v61, v59, vcc
  v_and_b32 v59, 15, v0
  s_waitcnt vmcnt(12) lgkmcnt(0)
  s_barrier
  v_mfma_f32_32x32x16_bf16 v[128:143], a[40:43], v[176:179], v[128:143]
  v_add_u32 v13, 0x14000, v13
  v_add_u32 v14, 0x14000, v14
  v_add_u32 v15, 0x14000, v15
  v_add_u32 v16, 0x14000, v16
  v_add_u32 v17, 0x14000, v17
  v_add_u32 v18, 0x14000, v18
  v_add_u32 v19, 0x14000, v19
  v_add_u32 v20, 0x14000, v20
  ds_read_b128 a[48:51], v13 offset:0
  ds_read_b128 v[160:163], v246 offset:8192
  s_add_u32 m0, s36, 0
  s_lshl_b32 s37, s101, 7
  buffer_load_dwordx4 v1, s[4:7], s37 offen offset:0 lds
  v_mfma_f32_32x32x16_bf16 v[144:159], a[40:43], v[180:183], v[144:159]
  ds_read_b128 v[164:167], v246 offset:12288
  ds_read_b128 a[160:163], v17 offset:0
  buffer_load_dwordx4 v2, s[4:7], s37 offen offset:1024 lds
  v_cmp_le_u32 s[88:89], s38, v59
  s_cmp_eq_u32 s40, 3
  s_cselect_b32 s47, 0, 1073741816
  s_cselect_b64 s[34:35], 0, -1
  s_add_u32 s46, s46, s47
  v_lshl_add_u32 v32, v59, 2, s46
  v_mfma_f32_32x32x16_bf16 v[128:143], a[44:47], v[184:187], v[128:143]
  ds_read_b128 a[52:55], v14 offset:0
  ds_read_b128 v[168:171], v247 offset:8192
  buffer_load_dwordx4 v3, s[4:7], s37 offen offset:2048 lds
  s_and_b32 s46, s2, 7
  s_lshl_b32 s46, s46, 7
  s_add_u32 s46, s46, s47
  v_mfma_f32_32x32x16_bf16 v[144:159], a[44:47], v[188:191], v[144:159]
  ds_read_b128 v[172:175], v247 offset:12288
  ds_read_b128 a[164:167], v18 offset:0
  buffer_load_dwordx4 v4, s[4:7], s37 offen offset:3072 lds
  s_add_u32 s46, s46, 13496320
  v_lshl_add_u32 v253, v57, 2, s46
  s_or_b64 s[88:89], s[88:89], s[34:35]
  s_waitcnt lgkmcnt(6)
  v_mfma_f32_32x32x16_bf16 v[128:143], a[48:51], v[160:163], v[128:143]
  ds_read_b128 a[56:59], v15 offset:0
  ds_read_b128 v[176:179], v248 offset:8192
  s_add_u32 m0, s36, 16384
  s_cmp_eq_u32 s42, 0
  s_cselect_b32 s37, s101, 16777215
  s_lshl_b32 s37, s37, 7
  buffer_load_dwordx4 v9, s[16:19], s37 offen offset:0 lds
  s_waitcnt lgkmcnt(7)
  v_mfma_f32_32x32x16_bf16 v[144:159], a[48:51], v[164:167], v[144:159]
  ds_read_b128 v[180:183], v248 offset:12288
  ds_read_b128 a[168:171], v19 offset:0
  buffer_load_dwordx4 v10, s[16:19], s37 offen offset:1024 lds
  s_and_b32 s46, s2, 1
  s_lshl_b32 s46, s46, 7
  s_add_u32 s46, s46, s47
  s_waitcnt lgkmcnt(6)
  v_mfma_f32_32x32x16_bf16 v[128:143], a[52:55], v[168:171], v[128:143]
  ds_read_b128 a[60:63], v16 offset:0
  ds_read_b128 v[184:187], v249 offset:8192
  buffer_load_dwordx4 v11, s[16:19], s37 offen offset:2048 lds
  v_mov_b32 v252, s46
  s_cmp_ge_u32 s39, 7
  s_cselect_b32 s3, 7, 0
  s_sub_u32 s3, s39, s3
  s_mul_i32 s46, s3, 344064
  s_mul_i32 s47, s40, 57344
  s_waitcnt lgkmcnt(7)
  v_mfma_f32_32x32x16_bf16 v[144:159], a[52:55], v[172:175], v[144:159]
  ds_read_b128 v[188:191], v249 offset:12288
  ds_read_b128 a[172:175], v20 offset:0
  buffer_load_dwordx4 v12, s[16:19], s37 offen offset:3072 lds
  s_add_u32 s46, s46, s47
  s_lshl_b32 s47, s41, 10
  s_add_u32 s46, s46, s47
  s_waitcnt vmcnt(12) lgkmcnt(0)
  s_barrier
  v_mfma_f32_32x32x16_bf16 v[128:143], a[56:59], v[176:179], v[128:143]
  ds_read_b128 a[64:67], v13 offset:16384
  ds_read_b128 v[160:163], v246 offset:49152
  s_add_u32 m0, s36, 32768
  s_mul_i32 s37, s87, 229376
  buffer_load_dwordx4 v5, s[8:11], s37 offen offset:0 lds
  s_add_u32 s46, s46, 11010048
  v_mfma_f32_32x32x16_bf16 v[144:159], a[56:59], v[180:183], v[144:159]
  ds_read_b128 v[164:167], v246 offset:53248
  ds_read_b128 a[176:179], v17 offset:16384
  buffer_load_dwordx4 v6, s[8:11], s37 offen offset:1024 lds
  v_lshl_add_u32 v250, v0, 4, s46
  v_xor_b32 v251, 1024, v250
  s_and_b32 s46, s38, 3
  v_mfma_f32_32x32x16_bf16 v[128:143], a[60:63], v[184:187], v[128:143]
  ds_read_b128 a[68:71], v14 offset:16384
  ds_read_b128 v[168:171], v247 offset:49152
  buffer_load_dwordx4 v7, s[12:15], s37 offen offset:2048 lds
  s_mul_i32 s46, s46, 0
  s_mul_i32 s47, s3, 0
  s_add_u32 s46, s46, s47
  v_mfma_f32_32x32x16_bf16 v[144:159], a[60:63], v[188:191], v[144:159]
  ds_read_b128 v[172:175], v247 offset:53248
  ds_read_b128 a[180:183], v18 offset:16384
  buffer_load_dwordx4 v8, s[12:15], s37 offen offset:3072 lds
  s_cmp_ge_u32 s46, 28
  s_cselect_b32 s47, 28, 0
  s_sub_u32 s43, s46, s47
  v_lshlrev_b32 v54, 16, v54
  v_lshlrev_b32 v55, 16, v55
  s_waitcnt lgkmcnt(6)
  v_mfma_f32_32x32x16_bf16 v[128:143], a[64:67], v[160:163], v[128:143]
  ds_read_b128 a[72:75], v15 offset:16384
  ds_read_b128 v[176:179], v248 offset:49152
  s_add_u32 m0, s36, 49152
  s_mul_i32 s37, s90, 229376
  buffer_load_dwordx4 v5, s[8:11], s37 offen offset:0 lds
  v_lshlrev_b32 v56, 16, v56
  s_waitcnt lgkmcnt(7)
  v_mfma_f32_32x32x16_bf16 v[144:159], a[64:67], v[164:167], v[144:159]
  ds_read_b128 v[180:183], v248 offset:53248
  ds_read_b128 a[184:187], v19 offset:16384
  buffer_load_dwordx4 v6, s[8:11], s37 offen offset:1024 lds
  v_mul_f32 v56, 0x3fb8aa3b, v56
  v_exp_f32 v56, v56
  s_waitcnt lgkmcnt(6)
  v_mfma_f32_32x32x16_bf16 v[128:143], a[68:71], v[168:171], v[128:143]
  ds_read_b128 a[76:79], v16 offset:16384
  ds_read_b128 v[184:187], v249 offset:49152
  buffer_load_dwordx4 v7, s[12:15], s37 offen offset:2048 lds
  s_nop 0
  v_cvt_pk_bf16_f32 v56, v56, v56
  v_lshlrev_b32 v56, 16, v56
  s_waitcnt lgkmcnt(7)
  v_mfma_f32_32x32x16_bf16 v[144:159], a[68:71], v[172:175], v[144:159]
  ds_read_b128 v[188:191], v249 offset:53248
  ds_read_b128 a[188:191], v20 offset:16384
  buffer_load_dwordx4 v8, s[12:15], s37 offen offset:3072 lds
  v_mul_f32 v208, v56, v54
  v_mul_f32 v209, v56, v55
  v_mul_f32 v208, 0x3fb8aa3b, v208
  s_waitcnt vmcnt(16) lgkmcnt(0)
  s_barrier
  v_mfma_f32_32x32x16_bf16 v[128:143], a[72:75], v[176:179], v[128:143]
  ds_read_b128 a[80:83], v13 offset:49152
  ds_read_b128 v[160:163], v246 offset:57344
  s_add_u32 m0, s36, 65536
  s_mul_i32 s37, s91, 229376
  buffer_load_dwordx4 v5, s[8:11], s37 offen offset:0 lds
  v_mul_f32 v209, 0.15915494, v209
  v_mfma_f32_32x32x16_bf16 v[144:159], a[72:75], v[180:183], v[144:159]
  ds_read_b128 v[164:167], v246 offset:61440
  ds_read_b128 a[192:195], v17 offset:49152
  buffer_load_dwordx4 v6, s[8:11], s37 offen offset:1024 lds
  v_exp_f32 v208, v208
  v_rndne_f32 v210, v209
  v_mfma_f32_32x32x16_bf16 v[128:143], a[76:79], v[184:187], v[128:143]
  ds_read_b128 a[84:87], v14 offset:49152
  ds_read_b128 v[168:171], v247 offset:57344
  buffer_load_dwordx4 v7, s[12:15], s37 offen offset:2048 lds
  v_sub_f32 v209, v209, v210
  v_cos_f32 v210, v209
  v_mfma_f32_32x32x16_bf16 v[144:159], a[76:79], v[188:191], v[144:159]
  ds_read_b128 v[172:175], v247 offset:61440
  ds_read_b128 a[196:199], v18 offset:49152
  buffer_load_dwordx4 v8, s[12:15], s37 offen offset:3072 lds
  v_sin_f32 v211, v209
  v_mul_f32 v212, v54, v54
  s_waitcnt lgkmcnt(6)
  v_mfma_f32_32x32x16_bf16 v[128:143], a[80:83], v[160:163], v[128:143]
  ds_read_b128 a[88:91], v15 offset:49152
  ds_read_b128 v[176:179], v248 offset:57344
  s_add_u32 m0, s36, 81920
  s_mul_i32 s37, s92, 229376
  buffer_load_dwordx4 v5, s[8:11], s37 offen offset:0 lds
  v_mul_f32 v34, v208, v210
  s_waitcnt lgkmcnt(7)
  v_mfma_f32_32x32x16_bf16 v[144:159], a[80:83], v[164:167], v[144:159]
  ds_read_b128 v[180:183], v248 offset:61440
  ds_read_b128 a[200:203], v19 offset:49152
  buffer_load_dwordx4 v6, s[8:11], s37 offen offset:1024 lds
  v_mul_f32 v35, v208, v211
  v_fma_f32 v212, v55, v55, v212
  v_rcp_f32 v212, v212
  s_waitcnt lgkmcnt(6)
  v_mfma_f32_32x32x16_bf16 v[128:143], a[84:87], v[168:171], v[128:143]
  ds_read_b128 a[92:95], v16 offset:49152
  ds_read_b128 v[184:187], v249 offset:57344
  buffer_load_dwordx4 v7, s[12:15], s37 offen offset:2048 lds
  v_add_f32 v208, -1.0, v34
  v_add_f32 v212, v212, v212
  v_mul_f32 v209, v208, v54
  s_waitcnt lgkmcnt(7)
  v_mfma_f32_32x32x16_bf16 v[144:159], a[84:87], v[172:175], v[144:159]
  ds_read_b128 v[188:191], v249 offset:61440
  ds_read_b128 a[204:207], v20 offset:49152
  buffer_load_dwordx4 v8, s[12:15], s37 offen offset:3072 lds
  v_mul_f32 v210, v35, v54
  v_fma_f32 v209, v35, v55, v209
  v_fma_f32 v210, -v208, v55, v210
  s_waitcnt vmcnt(16) lgkmcnt(0)
  s_barrier
  v_mfma_f32_32x32x16_bf16 v[128:143], a[88:91], v[176:179], v[128:143]
  v_add_u32 v13, 0xfffec000, v13
  v_add_u32 v14, 0xfffec000, v14
  v_add_u32 v15, 0xfffec000, v15
  v_add_u32 v16, 0xfffec000, v16
  v_add_u32 v17, 0xfffec000, v17
  v_add_u32 v18, 0xfffec000, v18
  v_add_u32 v19, 0xfffec000, v19
  v_add_u32 v20, 0xfffec000, v20
  v_add_u32 v246, 0xffff4000, v246
  v_add_u32 v247, 0xffff4000, v247
  v_add_u32 v248, 0xffff4000, v248
  v_add_u32 v249, 0xffff4000, v249
  ds_read_b128 a[96:99], v13 offset:0
  ds_read_b128 v[160:163], v246 offset:0
  s_add_u32 m0, s36, 98304
  s_mul_i32 s37, s93, 229376
  buffer_load_dwordx4 v5, s[8:11], s37 offen offset:0 lds
  v_mfma_f32_32x32x16_bf16 v[144:159], a[88:91], v[180:183], v[144:159]
  ds_read_b128 v[164:167], v246 offset:4096
  ds_read_b128 a[208:211], v17 offset:0
  buffer_load_dwordx4 v6, s[8:11], s37 offen offset:1024 lds
  v_mul_f32 v42, v209, v212
  v_mul_f32 v43, v210, v212
  v_mul_f32 v208, v35, v35
  v_mfma_f32_32x32x16_bf16 v[128:143], a[92:95], v[184:187], v[128:143]
  ds_read_b128 a[100:103], v14 offset:0
  ds_read_b128 v[168:171], v247 offset:0
  buffer_load_dwordx4 v7, s[12:15], s37 offen offset:2048 lds
  v_mul_f32 v209, v35, v34
  v_fma_f32 v214, v34, v34, -v208
  v_fma_f32 v215, v34, v35, v209
  v_mfma_f32_32x32x16_bf16 v[144:159], a[92:95], v[188:191], v[144:159]
  ds_read_b128 v[172:175], v247 offset:4096
  ds_read_b128 a[212:215], v18 offset:0
  buffer_load_dwordx4 v8, s[12:15], s37 offen offset:3072 lds
  v_mul_f32 v208, v215, v215
  v_mul_f32 v209, v215, v214
  v_fma_f32 v216, v214, v214, -v208
  s_waitcnt lgkmcnt(6)
  v_mfma_f32_32x32x16_bf16 v[128:143], a[96:99], v[160:163], v[128:143]
  ds_read_b128 a[104:107], v15 offset:0
  ds_read_b128 v[176:179], v248 offset:0
  s_add_u32 m0, s36, 114688
  s_mul_i32 s37, s100, 229376
  buffer_load_dwordx4 v5, s[8:11], s37 offen offset:0 lds
  v_fma_f32 v217, v214, v215, v209
  s_waitcnt lgkmcnt(7)
  v_mfma_f32_32x32x16_bf16 v[144:159], a[96:99], v[164:167], v[144:159]
  ds_read_b128 v[180:183], v248 offset:4096
  ds_read_b128 a[216:219], v19 offset:0
  v_mul_f32 v208, v217, v217
  v_mul_f32 v209, v217, v216
  v_fma_f32 v214, v216, v216, -v208
  v_fma_f32 v215, v216, v217, v209
  v_mul_f32 v208, v215, v215
  s_waitcnt lgkmcnt(6)
  v_mfma_f32_32x32x16_bf16 v[128:143], a[100:103], v[168:171], v[128:143]
  ds_read_b128 a[108:111], v16 offset:0
  ds_read_b128 v[184:187], v249 offset:0
  buffer_load_dwordx4 v6, s[8:11], s37 offen offset:1024 lds
  v_mul_f32 v209, v215, v214
  v_fma_f32 v36, v214, v214, -v208
  v_fma_f32 v37, v214, v215, v209
  s_waitcnt lgkmcnt(7)
  v_mfma_f32_32x32x16_bf16 v[144:159], a[100:103], v[172:175], v[144:159]
  ds_read_b128 v[188:191], v249 offset:4096
  ds_read_b128 a[220:223], v20 offset:0
  v_mul_f32 v208, v37, v37
  v_mul_f32 v209, v37, v36
  v_fma_f32 v214, v36, v36, -v208
  v_fma_f32 v215, v36, v37, v209
  v_mul_f32 v208, v215, v215
  s_waitcnt vmcnt(18) lgkmcnt(0)
  s_barrier
  v_mfma_f32_32x32x16_bf16 v[128:143], a[104:107], v[176:179], v[128:143]
  ds_read_b64_tr_b16 v[160:161], v21 offset:32768
  ds_read_b64_tr_b16 v[162:163], v21 offset:33280
  buffer_load_dwordx4 v7, s[12:15], s37 offen offset:2048 lds
  v_mul_f32 v209, v215, v214
  v_fma_f32 v216, v214, v214, -v208
  v_fma_f32 v217, v214, v215, v209
  v_mfma_f32_32x32x16_bf16 v[144:159], a[104:107], v[180:183], v[144:159]
  ds_read_b64_tr_b16 v[164:165], v22 offset:32768
  ds_read_b64_tr_b16 v[166:167], v22 offset:33280
  v_mul_f32 v208, v217, v217
  v_mul_f32 v209, v217, v216
  v_fma_f32 v38, v216, v216, -v208
  v_fma_f32 v39, v216, v217, v209
  v_cmp_le_u32 vcc, 32, v0
  v_mfma_f32_32x32x16_bf16 v[128:143], a[108:111], v[184:187], v[128:143]
  ds_read_b64_tr_b16 v[168:169], v21 offset:36864
  ds_read_b64_tr_b16 v[170:171], v21 offset:37376
  buffer_load_dwordx4 v8, s[12:15], s37 offen offset:3072 lds
  s_cmp_eq_u32 s42, 0
  s_cselect_b64 s[72:73], 0, -1
  s_cmp_eq_u32 s41, 0
  s_cselect_b64 s[74:75], 0, -1
  v_cndmask_b32 v218, 1.0, v36, vcc
  v_cndmask_b32 v219, 0, v37, vcc
  v_cndmask_b32 v214, 1.0, v214, s[72:73]
  v_mfma_f32_32x32x16_bf16 v[144:159], a[108:111], v[188:191], v[144:159]
  ds_read_b64_tr_b16 v[172:173], v22 offset:36864
  ds_read_b64_tr_b16 v[174:175], v22 offset:37376
  v_cndmask_b32 v215, 0, v215, s[72:73]
  v_cndmask_b32 v216, 1.0, v216, s[74:75]
  v_cndmask_b32 v217, 0, v217, s[74:75]
  v_mul_f32 v208, v219, v215
  v_mul_f32 v209, v219, v214
  s_waitcnt lgkmcnt(6)
  v_mfma_f32_32x32x16_bf16 v[64:79], v[160:163], a[0:3], 0
  ds_read_b64_tr_b16 v[176:177], v21 offset:40960
  s_add_u32 m0, s36, 131072
  s_mul_i32 s37, s101, 229376
  buffer_load_dwordx4 v5, s[8:11], s37 offen offset:0 lds
  v_fma_f32 v220, v218, v214, -v208
  v_fma_f32 v221, v218, v215, v209
  v_mfma_f32_32x32x16_bf16 v[80:95], v[160:163], a[112:115], 0
  ds_read_b64_tr_b16 v[178:179], v21 offset:41472
  v_mul_f32 v208, v221, v217
  v_mul_f32 v209, v221, v216
  v_fma_f32 v40, v220, v216, -v208
  v_fma_f32 v41, v220, v217, v209
  v_mov_b32 v56, v25
  v_mov_b32 v57, v25
  s_waitcnt lgkmcnt(6)
  v_mfma_f32_32x32x16_bf16 v[96:111], v[164:167], a[0:3], 0
  ds_read_b64_tr_b16 v[180:181], v22 offset:40960
  buffer_load_dwordx4 v6, s[8:11], s37 offen offset:1024 lds
  buffer_load_dword v33, v252, s[28:31], 0 offen sc0 sc1
  v_fma_f32 v58, v34, v128, v129
  v_fma_f32 v59, v34, v144, v145
  v_fma_f32 v46, -v35, v144, v58
  v_mfma_f32_32x32x16_bf16 v[112:127], v[164:167], a[112:115], 0
  ds_read_b64_tr_b16 v[182:183], v22 offset:41472
  v_fma_f32 v47, v35, v128, v59
  v_fma_f32 v58, v34, v46, v130
  v_fma_f32 v59, v34, v47, v146
  v_fma_f32 v50, -v35, v47, v58
  v_fma_f32 v51, v35, v46, v59
  v_fma_f32 v58, v34, v50, v131
  s_waitcnt lgkmcnt(6)
  v_mfma_f32_32x32x16_bf16 v[64:79], v[168:171], a[4:7], v[64:79]
  ds_read_b64_tr_b16 v[184:185], v21 offset:45056
  buffer_load_dwordx4 v7, s[12:15], s37 offen offset:2048 lds
  v_fma_f32 v59, v34, v51, v147
  v_fma_f32 v46, -v35, v51, v58
  v_fma_f32 v47, v35, v50, v59
  v_fma_f32 v58, v34, v46, v132
  v_mfma_f32_32x32x16_bf16 v[80:95], v[168:171], a[116:119], v[80:95]
  ds_read_b64_tr_b16 v[186:187], v21 offset:45568
  v_fma_f32 v59, v34, v47, v148
  v_fma_f32 v50, -v35, v47, v58
  v_fma_f32 v51, v35, v46, v59
  v_fma_f32 v58, v34, v50, v133
  v_fma_f32 v59, v34, v51, v149
  v_fma_f32 v46, -v35, v51, v58
  s_waitcnt lgkmcnt(6)
  v_mfma_f32_32x32x16_bf16 v[96:111], v[172:175], a[4:7], v[96:111]
  ds_read_b64_tr_b16 v[188:189], v22 offset:45056
  buffer_load_dwordx4 v8, s[12:15], s37 offen offset:3072 lds
  v_fma_f32 v47, v35, v50, v59
  v_fma_f32 v58, v34, v46, v134
  v_fma_f32 v59, v34, v47, v150
  v_fma_f32 v50, -v35, v47, v58
  v_mfma_f32_32x32x16_bf16 v[112:127], v[172:175], a[116:119], v[112:127]
  ds_read_b64_tr_b16 v[190:191], v22 offset:45568
  v_fma_f32 v51, v35, v46, v59
  v_fma_f32 v58, v34, v50, v135
  v_fma_f32 v59, v34, v51, v151
  v_fma_f32 v46, -v35, v51, v58
  v_fma_f32 v47, v35, v50, v59
  v_fma_f32 v58, v34, v46, v136
  v_fma_f32 v59, v34, v47, v152
  v_fma_f32 v50, -v35, v47, v58
  v_fma_f32 v51, v35, v46, v59
  v_fma_f32 v58, v34, v50, v137
  v_fma_f32 v59, v34, v51, v153
  v_fma_f32 v46, -v35, v51, v58
  v_fma_f32 v47, v35, v50, v59
  v_fma_f32 v58, v34, v46, v138
  v_fma_f32 v59, v34, v47, v154
  v_fma_f32 v50, -v35, v47, v58
  v_fma_f32 v51, v35, v46, v59
  v_fma_f32 v58, v34, v50, v139
  v_fma_f32 v59, v34, v51, v155
  v_fma_f32 v46, -v35, v51, v58
  v_fma_f32 v47, v35, v50, v59
  v_fma_f32 v58, v34, v46, v140
  v_fma_f32 v59, v34, v47, v156
  v_fma_f32 v50, -v35, v47, v58
  v_fma_f32 v51, v35, v46, v59
  v_fma_f32 v58, v34, v50, v141
  v_fma_f32 v59, v34, v51, v157
  v_fma_f32 v46, -v35, v51, v58
  v_fma_f32 v47, v35, v50, v59
  v_fma_f32 v58, v34, v46, v142
  v_fma_f32 v59, v34, v47, v158
  v_fma_f32 v50, -v35, v47, v58
  v_fma_f32 v51, v35, v46, v59
  v_fma_f32 v58, v34, v50, v143
  v_fma_f32 v59, v34, v51, v159
  v_fma_f32 v46, -v35, v51, v58
  v_fma_f32 v47, v35, v50, v59
  ds_write_b64 v26, v[46:47] offset:1792
  s_waitcnt vmcnt(17) lgkmcnt(0)
  s_barrier
  v_mfma_f32_32x32x16_bf16 v[64:79], v[176:179], a[8:11], v[64:79]
  ds_read_b64_tr_b16 v[160:161], v21 offset:49152
  s_add_u32 m0, s36, 0
  s_mul_i32 s37, s87, 229376
  s_add_u32 s37, s37, 128
  buffer_load_dwordx4 v5, s[8:11], s37 offen offset:0 lds
  v_mfma_f32_32x32x16_bf16 v[80:95], v[176:179], a[120:123], v[80:95]
  ds_read_b64_tr_b16 v[162:163], v21 offset:49664
  ds_read_b64 v[232:233], v26 offset:0
  ds_read_b64 v[234:235], v26 offset:256
  ds_read_b64 v[236:237], v26 offset:512
  ds_read_b64 v[238:239], v26 offset:768
  ds_read_b64 v[240:241], v26 offset:1024
  ds_read_b64 v[242:243], v26 offset:1280
  v_mfma_f32_32x32x16_bf16 v[96:111], v[180:183], a[8:11], v[96:111]
  ds_read_b64_tr_b16 v[164:165], v22 offset:49152
  buffer_load_dwordx4 v6, s[8:11], s37 offen offset:1024 lds
  ds_read_b64 v[244:245], v26 offset:1536
  s_waitcnt lgkmcnt(6)
  v_fma_f32 v58, v36, v232, v234
  v_fma_f32 v59, v36, v233, v235
  v_fma_f32 v50, -v37, v233, v58
  v_mfma_f32_32x32x16_bf16 v[112:127], v[180:183], a[120:123], v[112:127]
  ds_read_b64_tr_b16 v[166:167], v22 offset:49664
  v_fma_f32 v51, v37, v232, v59
  s_waitcnt lgkmcnt(6)
  v_fma_f32 v58, v36, v50, v236
  v_fma_f32 v59, v36, v51, v237
  v_fma_f32 v44, -v37, v51, v58
  v_fma_f32 v45, v37, v50, v59
  s_waitcnt lgkmcnt(5)
  v_fma_f32 v58, v36, v44, v238
  v_mfma_f32_32x32x16_bf16 v[64:79], v[184:187], a[12:15], v[64:79]
  ds_read_b64_tr_b16 v[168:169], v21 offset:53248
  buffer_load_dwordx4 v7, s[12:15], s37 offen offset:2048 lds
  v_fma_f32 v59, v36, v45, v239
  v_fma_f32 v50, -v37, v45, v58
  v_fma_f32 v51, v37, v44, v59
  s_waitcnt lgkmcnt(5)
  v_fma_f32 v58, v36, v50, v240
  v_mfma_f32_32x32x16_bf16 v[80:95], v[184:187], a[124:127], v[80:95]
  ds_read_b64_tr_b16 v[170:171], v21 offset:53760
  v_fma_f32 v59, v36, v51, v241
  v_fma_f32 v44, -v37, v51, v58
  v_fma_f32 v45, v37, v50, v59
  s_waitcnt lgkmcnt(5)
  v_fma_f32 v58, v36, v44, v242
  v_fma_f32 v59, v36, v45, v243
  v_fma_f32 v50, -v37, v45, v58
  v_mfma_f32_32x32x16_bf16 v[96:111], v[188:191], a[12:15], v[96:111]
  ds_read_b64_tr_b16 v[172:173], v22 offset:53248
  buffer_load_dwordx4 v8, s[12:15], s37 offen offset:3072 lds
  v_fma_f32 v51, v37, v44, v59
  s_waitcnt lgkmcnt(4)
  v_fma_f32 v58, v36, v50, v244
  v_fma_f32 v59, v36, v51, v245
  v_fma_f32 v44, -v37, v51, v58
  v_mfma_f32_32x32x16_bf16 v[112:127], v[188:191], a[124:127], v[112:127]
  ds_read_b64_tr_b16 v[174:175], v22 offset:53760
  v_fma_f32 v45, v37, v50, v59
  v_fma_f32 v58, v36, v44, v46
  v_fma_f32 v59, v36, v45, v47
  v_fma_f32 v52, -v37, v45, v58
  v_fma_f32 v53, v37, v44, v59
  buffer_store_dwordx2 v[52:53], v29, s[24:27], 0 offen sc0 sc1
  v_mfma_f32_32x32x16_bf16 v[64:79], v[160:163], a[16:19], v[64:79]
  ds_read_b64_tr_b16 v[176:177], v21 offset:57344
  s_add_u32 m0, s36, 16384
  s_mul_i32 s37, s90, 229376
  s_add_u32 s37, s37, 128
  buffer_load_dwordx4 v5, s[8:11], s37 offen offset:0 lds
  v_mfma_f32_32x32x16_bf16 v[80:95], v[160:163], a[128:131], v[80:95]
  ds_read_b64_tr_b16 v[178:179], v21 offset:57856
  s_waitcnt lgkmcnt(6)
  v_mfma_f32_32x32x16_bf16 v[96:111], v[164:167], a[16:19], v[96:111]
  ds_read_b64_tr_b16 v[180:181], v22 offset:57344
  buffer_load_dwordx4 v6, s[8:11], s37 offen offset:1024 lds
  v_mfma_f32_32x32x16_bf16 v[112:127], v[164:167], a[128:131], v[112:127]
  ds_read_b64_tr_b16 v[182:183], v22 offset:57856
  s_waitcnt lgkmcnt(6)
  v_mfma_f32_32x32x16_bf16 v[64:79], v[168:171], a[20:23], v[64:79]
  ds_read_b64_tr_b16 v[184:185], v21 offset:61440
  buffer_load_dwordx4 v7, s[12:15], s37 offen offset:2048 lds
  v_mfma_f32_32x32x16_bf16 v[80:95], v[168:171], a[132:135], v[80:95]
  ds_read_b64_tr_b16 v[186:187], v21 offset:61952
  s_waitcnt lgkmcnt(6)
  v_mfma_f32_32x32x16_bf16 v[96:111], v[172:175], a[20:23], v[96:111]
  ds_read_b64_tr_b16 v[188:189], v22 offset:61440
  buffer_load_dwordx4 v8, s[12:15], s37 offen offset:3072 lds
  v_mfma_f32_32x32x16_bf16 v[112:127], v[172:175], a[132:135], v[112:127]
  ds_read_b64_tr_b16 v[190:191], v22 offset:61952
  s_waitcnt lgkmcnt(6)
  v_mfma_f32_32x32x16_bf16 v[64:79], v[176:179], a[24:27], v[64:79]
  v_add_u32 v21, 0x10000, v21
  v_add_u32 v22, 0x10000, v22
  ds_read_b64_tr_b16 v[160:161], v21 offset:0
  s_add_u32 m0, s36, 32768
  s_mul_i32 s37, s91, 229376
  s_add_u32 s37, s37, 128
  buffer_load_dwordx4 v5, s[8:11], s37 offen offset:0 lds
  v_mfma_f32_32x32x16_bf16 v[80:95], v[176:179], a[136:139], v[80:95]
  ds_read_b64_tr_b16 v[162:163], v21 offset:512
  s_waitcnt lgkmcnt(6)
  v_mfma_f32_32x32x16_bf16 v[96:111], v[180:183], a[24:27], v[96:111]
  ds_read_b64_tr_b16 v[164:165], v22 offset:0
  v_mfma_f32_32x32x16_bf16 v[112:127], v[180:183], a[136:139], v[112:127]
  ds_read_b64_tr_b16 v[166:167], v22 offset:512
  s_waitcnt lgkmcnt(6)
  v_mfma_f32_32x32x16_bf16 v[64:79], v[184:187], a[28:31], v[64:79]
  ds_read_b64_tr_b16 v[168:169], v21 offset:4096
  buffer_load_dwordx4 v6, s[8:11], s37 offen offset:1024 lds
  v_mfma_f32_32x32x16_bf16 v[80:95], v[184:187], a[140:143], v[80:95]
  ds_read_b64_tr_b16 v[170:171], v21 offset:4608
  s_waitcnt lgkmcnt(6)
  v_mfma_f32_32x32x16_bf16 v[96:111], v[188:191], a[28:31], v[96:111]
  ds_read_b64_tr_b16 v[172:173], v22 offset:4096
  v_mfma_f32_32x32x16_bf16 v[112:127], v[188:191], a[140:143], v[112:127]
  ds_read_b64_tr_b16 v[174:175], v22 offset:4608
  s_waitcnt lgkmcnt(6)
  v_mfma_f32_32x32x16_bf16 v[64:79], v[160:163], a[32:35], v[64:79]
  ds_read_b64_tr_b16 v[176:177], v21 offset:8192
  buffer_load_dwordx4 v7, s[12:15], s37 offen offset:2048 lds
  v_mfma_f32_32x32x16_bf16 v[80:95], v[160:163], a[144:147], v[80:95]
  ds_read_b64_tr_b16 v[178:179], v21 offset:8704
  s_waitcnt lgkmcnt(6)
  v_mfma_f32_32x32x16_bf16 v[96:111], v[164:167], a[32:35], v[96:111]
  ds_read_b64_tr_b16 v[180:181], v22 offset:8192
  v_mfma_f32_32x32x16_bf16 v[112:127], v[164:167], a[144:147], v[112:127]
  ds_read_b64_tr_b16 v[182:183], v22 offset:8704
  s_waitcnt lgkmcnt(6)
  v_mfma_f32_32x32x16_bf16 v[64:79], v[168:171], a[36:39], v[64:79]
  ds_read_b64_tr_b16 v[184:185], v21 offset:12288
  buffer_load_dwordx4 v8, s[12:15], s37 offen offset:3072 lds
  v_mfma_f32_32x32x16_bf16 v[80:95], v[168:171], a[148:151], v[80:95]
  ds_read_b64_tr_b16 v[186:187], v21 offset:12800
  s_waitcnt lgkmcnt(6)
  v_mfma_f32_32x32x16_bf16 v[96:111], v[172:175], a[36:39], v[96:111]
  ds_read_b64_tr_b16 v[188:189], v22 offset:12288
  v_mfma_f32_32x32x16_bf16 v[112:127], v[172:175], a[148:151], v[112:127]
  ds_read_b64_tr_b16 v[190:191], v22 offset:12800
  s_waitcnt vmcnt(22) lgkmcnt(0)
  s_barrier
  v_mfma_f32_32x32x16_bf16 v[64:79], v[176:179], a[40:43], v[64:79]
  ds_read_b64_tr_b16 v[160:161], v21 offset:16384
  s_add_u32 m0, s36, 49152
  s_mul_i32 s37, s92, 229376
  s_add_u32 s37, s37, 128
  buffer_load_dwordx4 v5, s[8:11], s37 offen offset:0 lds
  v_mfma_f32_32x32x16_bf16 v[80:95], v[176:179], a[152:155], v[80:95]
  ds_read_b64_tr_b16 v[162:163], v21 offset:16896
  v_mfma_f32_32x32x16_bf16 v[96:111], v[180:183], a[40:43], v[96:111]
  ds_read_b64_tr_b16 v[164:165], v22 offset:16384
  v_mfma_f32_32x32x16_bf16 v[112:127], v[180:183], a[152:155], v[112:127]
  ds_read_b64_tr_b16 v[166:167], v22 offset:16896
  v_mfma_f32_32x32x16_bf16 v[64:79], v[184:187], a[44:47], v[64:79]
  ds_read_b64_tr_b16 v[168:169], v21 offset:20480
  buffer_load_dwordx4 v6, s[8:11], s37 offen offset:1024 lds
  v_mfma_f32_32x32x16_bf16 v[80:95], v[184:187], a[156:159], v[80:95]
  ds_read_b64_tr_b16 v[170:171], v21 offset:20992
  v_mfma_f32_32x32x16_bf16 v[96:111], v[188:191], a[44:47], v[96:111]
  ds_read_b64_tr_b16 v[172:173], v22 offset:20480
  v_mfma_f32_32x32x16_bf16 v[112:127], v[188:191], a[156:159], v[112:127]
  ds_read_b64_tr_b16 v[174:175], v22 offset:20992
  s_waitcnt lgkmcnt(6)
  v_mfma_f32_32x32x16_bf16 v[64:79], v[160:163], a[48:51], v[64:79]
  ds_read_b64_tr_b16 v[176:177], v21 offset:24576
  buffer_load_dwordx4 v7, s[12:15], s37 offen offset:2048 lds
  v_mfma_f32_32x32x16_bf16 v[80:95], v[160:163], a[160:163], v[80:95]
  ds_read_b64_tr_b16 v[178:179], v21 offset:25088
  s_waitcnt vmcnt(18)
  v_cmp_ne_u32 vcc, 0, v33
  s_nop 1
  s_or_b64 s[94:95], vcc, s[34:35]
  s_cmp_eq_u64 s[94:95], -1
  s_cbranch_scc1 L_gotT
  s_mov_b32 s46, 0
L_spinT:
  s_sleep 1
  buffer_load_dword v33, v252, s[28:31], 0 offen sc0 sc1
  s_waitcnt vmcnt(0)
  v_cmp_ne_u32 vcc, 0, v33
  s_nop 1
  s_or_b64 s[94:95], vcc, s[34:35]
  s_cmp_eq_u64 s[94:95], -1
  s_cbranch_scc1 L_gotT
  s_add_u32 s46, s46, 1
  s_cmp_lt_u32 s46, 0x40000
  s_cbranch_scc1 L_spinT
L_gotT:
  s_waitcnt vmcnt(11)
  buffer_store_dword v33, v30, s[20:23], 0 offen sc0 sc1
  s_waitcnt lgkmcnt(6)
  v_mfma_f32_32x32x16_bf16 v[96:111], v[164:167], a[48:51], v[96:111]
  ds_read_b64_tr_b16 v[180:181], v22 offset:24576
  v_mfma_f32_32x32x16_bf16 v[112:127], v[164:167], a[160:163], v[112:127]
  ds_read_b64_tr_b16 v[182:183], v22 offset:25088
  s_waitcnt lgkmcnt(6)
  v_mfma_f32_32x32x16_bf16 v[64:79], v[168:171], a[52:55], v[64:79]
  ds_read_b64_tr_b16 v[184:185], v21 offset:28672
  buffer_load_dwordx4 v8, s[12:15], s37 offen offset:3072 lds
  v_mfma_f32_32x32x16_bf16 v[80:95], v[168:171], a[164:167], v[80:95]
  ds_read_b64_tr_b16 v[186:187], v21 offset:29184
  s_waitcnt lgkmcnt(6)
  v_mfma_f32_32x32x16_bf16 v[96:111], v[172:175], a[52:55], v[96:111]
  ds_read_b64_tr_b16 v[188:189], v22 offset:28672
  v_mfma_f32_32x32x16_bf16 v[112:127], v[172:175], a[164:167], v[112:127]
  ds_read_b64_tr_b16 v[190:191], v22 offset:29184
  s_waitcnt lgkmcnt(6)
  v_mfma_f32_32x32x16_bf16 v[64:79], v[176:179], a[56:59], v[64:79]
  ds_read_b64_tr_b16 v[160:161], v21 offset:32768
  s_add_u32 m0, s36, 65536
  s_mul_i32 s37, s93, 229376
  s_add_u32 s37, s37, 128
  buffer_load_dwordx4 v5, s[8:11], s37 offen offset:0 lds
  v_mfma_f32_32x32x16_bf16 v[80:95], v[176:179], a[168:171], v[80:95]
  ds_read_b64_tr_b16 v[162:163], v21 offset:33280
  s_waitcnt lgkmcnt(6)
  v_mfma_f32_32x32x16_bf16 v[96:111], v[180:183], a[56:59], v[96:111]
  ds_read_b64_tr_b16 v[164:165], v22 offset:32768
  v_mfma_f32_32x32x16_bf16 v[112:127], v[180:183], a[168:171], v[112:127]
  ds_read_b64_tr_b16 v[166:167], v22 offset:33280
  s_waitcnt lgkmcnt(6)
  v_mfma_f32_32x32x16_bf16 v[64:79], v[184:187], a[60:63], v[64:79]
  ds_read_b64_tr_b16 v[168:169], v21 offset:36864
  buffer_load_dwordx4 v6, s[8:11], s37 offen offset:1024 lds
  v_mfma_f32_32x32x16_bf16 v[80:95], v[184:187], a[172:175], v[80:95]
  ds_read_b64_tr_b16 v[170:171], v21 offset:37376
  s_waitcnt lgkmcnt(6)
  v_mfma_f32_32x32x16_bf16 v[96:111], v[188:191], a[60:63], v[96:111]
  ds_read_b64_tr_b16 v[172:173], v22 offset:36864
  v_mfma_f32_32x32x16_bf16 v[112:127], v[188:191], a[172:175], v[112:127]
  ds_read_b64_tr_b16 v[174:175], v22 offset:37376
  s_waitcnt lgkmcnt(6)
  v_mfma_f32_32x32x16_bf16 v[64:79], v[160:163], a[64:67], v[64:79]
  ds_read_b64_tr_b16 v[176:177], v21 offset:40960
  buffer_load_dwordx4 v7, s[12:15], s37 offen offset:2048 lds
  v_mfma_f32_32x32x16_bf16 v[80:95], v[160:163], a[176:179], v[80:95]
  ds_read_b64_tr_b16 v[178:179], v21 offset:41472
  s_waitcnt lgkmcnt(6)
  v_mfma_f32_32x32x16_bf16 v[96:111], v[164:167], a[64:67], v[96:111]
  ds_read_b64_tr_b16 v[180:181], v22 offset:40960
  v_mfma_f32_32x32x16_bf16 v[112:127], v[164:167], a[176:179], v[112:127]
  ds_read_b64_tr_b16 v[182:183], v22 offset:41472
  s_waitcnt lgkmcnt(6)
  v_mfma_f32_32x32x16_bf16 v[64:79], v[168:171], a[68:71], v[64:79]
  ds_read_b64_tr_b16 v[184:185], v21 offset:45056
  buffer_load_dwordx4 v8, s[12:15], s37 offen offset:3072 lds
  v_mfma_f32_32x32x16_bf16 v[80:95], v[168:171], a[180:183], v[80:95]
  ds_read_b64_tr_b16 v[186:187], v21 offset:45568
  s_waitcnt lgkmcnt(6)
  v_mfma_f32_32x32x16_bf16 v[96:111], v[172:175], a[68:71], v[96:111]
  ds_read_b64_tr_b16 v[188:189], v22 offset:45056
  v_mfma_f32_32x32x16_bf16 v[112:127], v[172:175], a[180:183], v[112:127]
  ds_read_b64_tr_b16 v[190:191], v22 offset:45568
  s_waitcnt lgkmcnt(0)
  s_barrier
  v_mfma_f32_32x32x16_bf16 v[64:79], v[176:179], a[72:75], v[64:79]
  ds_read_b64_tr_b16 v[160:161], v21 offset:49152
  s_add_u32 m0, s36, 81920
  s_mul_i32 s37, s100, 229376
  s_add_u32 s37, s37, 128
  buffer_load_dwordx4 v5, s[8:11], s37 offen offset:0 lds
  v_mfma_f32_32x32x16_bf16 v[80:95], v[176:179], a[184:187], v[80:95]
  ds_read_b64_tr_b16 v[162:163], v21 offset:49664
  v_mfma_f32_32x32x16_bf16 v[96:111], v[180:183], a[72:75], v[96:111]
  ds_read_b64_tr_b16 v[164:165], v22 offset:49152
  v_mfma_f32_32x32x16_bf16 v[112:127], v[180:183], a[184:187], v[112:127]
  ds_read_b64_tr_b16 v[166:167], v22 offset:49664
  v_mfma_f32_32x32x16_bf16 v[64:79], v[184:187], a[76:79], v[64:79]
  ds_read_b64_tr_b16 v[168:169], v21 offset:53248
  buffer_load_dwordx4 v6, s[8:11], s37 offen offset:1024 lds
  v_mfma_f32_32x32x16_bf16 v[80:95], v[184:187], a[188:191], v[80:95]
  ds_read_b64_tr_b16 v[170:171], v21 offset:53760
  v_mfma_f32_32x32x16_bf16 v[96:111], v[188:191], a[76:79], v[96:111]
  ds_read_b64_tr_b16 v[172:173], v22 offset:53248
  v_mfma_f32_32x32x16_bf16 v[112:127], v[188:191], a[188:191], v[112:127]
  ds_read_b64_tr_b16 v[174:175], v22 offset:53760
  s_waitcnt lgkmcnt(6)
  v_mfma_f32_32x32x16_bf16 v[64:79], v[160:163], a[80:83], v[64:79]
  ds_read_b64_tr_b16 v[176:177], v21 offset:57344
  buffer_load_dwordx4 v7, s[12:15], s37 offen offset:2048 lds
  v_mfma_f32_32x32x16_bf16 v[80:95], v[160:163], a[192:195], v[80:95]
  ds_read_b64_tr_b16 v[178:179], v21 offset:57856
  s_waitcnt lgkmcnt(6)
  v_mfma_f32_32x32x16_bf16 v[96:111], v[164:167], a[80:83], v[96:111]
  ds_read_b64_tr_b16 v[180:181], v22 offset:57344
  v_mfma_f32_32x32x16_bf16 v[112:127], v[164:167], a[192:195], v[112:127]
  ds_read_b64_tr_b16 v[182:183], v22 offset:57856
  s_waitcnt lgkmcnt(6)
  v_mfma_f32_32x32x16_bf16 v[64:79], v[168:171], a[84:87], v[64:79]
  ds_read_b64_tr_b16 v[184:185], v21 offset:61440
  buffer_load_dwordx4 v8, s[12:15], s37 offen offset:3072 lds
  v_mfma_f32_32x32x16_bf16 v[80:95], v[168:171], a[196:199], v[80:95]
  ds_read_b64_tr_b16 v[186:187], v21 offset:61952
  s_waitcnt lgkmcnt(6)
  v_mfma_f32_32x32x16_bf16 v[96:111], v[172:175], a[84:87], v[96:111]
  ds_read_b64_tr_b16 v[188:189], v22 offset:61440
  v_mfma_f32_32x32x16_bf16 v[112:127], v[172:175], a[196:199], v[112:127]
  ds_read_b64_tr_b16 v[190:191], v22 offset:61952
  s_waitcnt lgkmcnt(6)
  v_mfma_f32_32x32x16_bf16 v[64:79], v[176:179], a[88:91], v[64:79]
  v_add_u32 v21, 0x10000, v21
  v_add_u32 v22, 0x10000, v22
  ds_read_b64_tr_b16 v[160:161], v21 offset:0
  s_add_u32 m0, s36, 98304
  s_mul_i32 s37, s101, 229376
  s_add_u32 s37, s37, 128
  buffer_load_dwordx4 v5, s[8:11], s37 offen offset:0 lds
  v_mfma_f32_32x32x16_bf16 v[80:95], v[176:179], a[200:203], v[80:95]
  ds_read_b64_tr_b16 v[162:163], v21 offset:512
  s_waitcnt lgkmcnt(6)
  v_mfma_f32_32x32x16_bf16 v[96:111], v[180:183], a[88:91], v[96:111]
  ds_read_b64_tr_b16 v[164:165], v22 offset:0
  v_mfma_f32_32x32x16_bf16 v[112:127], v[180:183], a[200:203], v[112:127]
  ds_read_b64_tr_b16 v[166:167], v22 offset:512
  s_waitcnt lgkmcnt(6)
  v_mfma_f32_32x32x16_bf16 v[64:79], v[184:187], a[92:95], v[64:79]
  ds_read_b64_tr_b16 v[168:169], v21 offset:4096
  buffer_load_dwordx4 v6, s[8:11], s37 offen offset:1024 lds
  buffer_load_dword v1, v253, s[20:23], 0 offen sc0 sc1
  v_mfma_f32_32x32x16_bf16 v[80:95], v[184:187], a[204:207], v[80:95]
  ds_read_b64_tr_b16 v[170:171], v21 offset:4608
  s_waitcnt lgkmcnt(6)
  v_mfma_f32_32x32x16_bf16 v[96:111], v[188:191], a[92:95], v[96:111]
  ds_read_b64_tr_b16 v[172:173], v22 offset:4096
  v_mfma_f32_32x32x16_bf16 v[112:127], v[188:191], a[204:207], v[112:127]
  ds_read_b64_tr_b16 v[174:175], v22 offset:4608
  s_waitcnt lgkmcnt(6)
  v_mfma_f32_32x32x16_bf16 v[64:79], v[160:163], a[96:99], v[64:79]
  ds_read_b64_tr_b16 v[176:177], v21 offset:8192
  buffer_load_dwordx4 v7, s[12:15], s37 offen offset:2048 lds
  v_mfma_f32_32x32x16_bf16 v[80:95], v[160:163], a[208:211], v[80:95]
  ds_read_b64_tr_b16 v[178:179], v21 offset:8704
  s_waitcnt lgkmcnt(6)
  v_mfma_f32_32x32x16_bf16 v[96:111], v[164:167], a[96:99], v[96:111]
  ds_read_b64_tr_b16 v[180:181], v22 offset:8192
  v_mfma_f32_32x32x16_bf16 v[112:127], v[164:167], a[208:211], v[112:127]
  ds_read_b64_tr_b16 v[182:183], v22 offset:8704
  s_waitcnt lgkmcnt(6)
  v_mfma_f32_32x32x16_bf16 v[64:79], v[168:171], a[100:103], v[64:79]
  ds_read_b64_tr_b16 v[184:185], v21 offset:12288
  buffer_load_dwordx4 v8, s[12:15], s37 offen offset:3072 lds
  v_mfma_f32_32x32x16_bf16 v[80:95], v[168:171], a[212:215], v[80:95]
  ds_read_b64_tr_b16 v[186:187], v21 offset:12800
  s_waitcnt lgkmcnt(6)
  v_mfma_f32_32x32x16_bf16 v[96:111], v[172:175], a[100:103], v[96:111]
  ds_read_b64_tr_b16 v[188:189], v22 offset:12288
  v_mfma_f32_32x32x16_bf16 v[112:127], v[172:175], a[212:215], v[112:127]
  ds_read_b64_tr_b16 v[190:191], v22 offset:12800
  s_waitcnt lgkmcnt(6)
  v_mfma_f32_32x32x16_bf16 v[64:79], v[176:179], a[104:107], v[64:79]
  v_mfma_f32_32x32x16_bf16 v[80:95], v[176:179], a[216:219], v[80:95]
  s_waitcnt lgkmcnt(4)
  v_mfma_f32_32x32x16_bf16 v[96:111], v[180:183], a[104:107], v[96:111]
  v_mfma_f32_32x32x16_bf16 v[112:127], v[180:183], a[216:219], v[112:127]
  s_waitcnt vmcnt(22) lgkmcnt(0)
  s_waitcnt vmcnt(2)
  v_cmp_eq_u32 vcc, v33, v1
  s_nop 1
  s_or_b64 s[94:95], vcc, s[34:35]
  s_cmp_eq_u64 s[94:95], -1
  s_cbranch_scc1 L_gotP
  s_mov_b32 s46, 0
L_spinP:
  s_sleep 1
  buffer_load_dword v1, v253, s[20:23], 0 offen sc0 sc1
  s_waitcnt vmcnt(0)
  v_cmp_eq_u32 vcc, v33, v1
  s_nop 1
  s_or_b64 s[94:95], vcc, s[34:35]
  s_cmp_eq_u64 s[94:95], -1
  s_cbranch_scc1 L_gotP
  s_add_u32 s46, s46, 1
  s_cmp_lt_u32 s46, 0x40000
  s_cbranch_scc1 L_spinP
L_gotP:
  s_barrier
  v_mfma_f32_32x32x16_bf16 v[64:79], v[184:187], a[108:111], v[64:79]
  v_add_u32 v21, 0xfffe0000, v21
  v_add_u32 v22, 0xfffe0000, v22
  ds_read_b64_tr_b16 v[192:193], v21 offset:0
  ds_read_b64_tr_b16 v[194:195], v21 offset:512
  v_mfma_f32_32x32x16_bf16 v[80:95], v[184:187], a[220:223], v[80:95]
  ds_read_b64_tr_b16 v[196:197], v22 offset:0
  ds_read_b64_tr_b16 v[198:199], v22 offset:512
  v_mfma_f32_32x32x16_bf16 v[96:111], v[188:191], a[108:111], v[96:111]
  v_mfma_f32_32x32x16_bf16 v[112:127], v[188:191], a[220:223], v[112:127]
  s_waitcnt lgkmcnt(2)
  v_mfma_f32_32x32x16_bf16 v[160:175], v[192:195], a[0:3], 0
  ds_read_b64_tr_b16 v[200:201], v21 offset:4096
  ds_read_b64_tr_b16 v[202:203], v21 offset:4608
  v_mfma_f32_32x32x16_bf16 v[176:191], v[192:195], a[112:115], 0
  ds_read_b64_tr_b16 v[204:205], v22 offset:4096
  ds_read_b64_tr_b16 v[206:207], v22 offset:4608
  s_waitcnt lgkmcnt(4)
  v_mfma_f32_32x32x16_bf16 a[224:239], v[196:199], a[0:3], 0
  v_mul_f32 v208, v64, v64
  v_mul_f32 v220, v80, v80
  v_mul_f32 v209, v65, v65
  v_mul_f32 v221, v81, v81
  v_fma_f32 v208, v208, s44, v25
  v_fma_f32 v220, v220, s44, v25
  v_fma_f32 v209, v209, s44, v25
  v_mfma_f32_32x32x16_bf16 a[240:255], v[196:199], a[112:115], 0
  v_fma_f32 v221, v221, s44, v25
  v_mul_f32 v208, v208, v64
  v_mul_f32 v220, v220, v80
  v_mul_f32 v209, v209, v65
  v_mul_f32 v221, v221, v81
  v_exp_f32 v208, v208
  s_waitcnt lgkmcnt(2)
  v_mfma_f32_32x32x16_bf16 v[160:175], v[200:203], a[4:7], v[160:175]
  ds_read_b64_tr_b16 v[192:193], v21 offset:8192
  ds_read_b64_tr_b16 v[194:195], v21 offset:8704
  v_exp_f32 v220, v220
  v_mul_f32 v210, v64, v72
  v_mul_f32 v222, v80, v88
  v_exp_f32 v209, v209
  v_mfma_f32_32x32x16_bf16 v[176:191], v[200:203], a[116:119], v[176:191]
  ds_read_b64_tr_b16 v[196:197], v22 offset:8192
  ds_read_b64_tr_b16 v[198:199], v22 offset:8704
  v_exp_f32 v221, v221
  v_mul_f32 v211, v65, v73
  v_mul_f32 v223, v81, v89
  v_add_f32 v208, 1.0, v208
  s_waitcnt lgkmcnt(4)
  v_mfma_f32_32x32x16_bf16 a[224:239], v[204:207], a[4:7], a[224:239]
  s_mov_b32 s87, 0
  buffer_load_dwordx4 a[0:3], v250, s[20:23], s87 offen offset:0 sc1
  v_add_f32 v220, 1.0, v220
  v_add_f32 v209, 1.0, v209
  v_add_f32 v221, 1.0, v221
  v_rcp_f32 v208, v208
  v_mfma_f32_32x32x16_bf16 a[240:255], v[204:207], a[116:119], a[240:255]
  buffer_load_dwordx4 a[112:115], v251, s[20:23], s87 offen offset:0 sc1
  v_rcp_f32 v220, v220
  v_rcp_f32 v209, v209
  v_rcp_f32 v221, v221
  s_waitcnt lgkmcnt(2)
  v_mfma_f32_32x32x16_bf16 v[160:175], v[192:195], a[8:11], v[160:175]
  ds_read_b64_tr_b16 v[200:201], v21 offset:12288
  ds_read_b64_tr_b16 v[202:203], v21 offset:12800
  v_mul_f32 v208, v208, v210
  v_mul_f32 v220, v220, v222
  v_mul_f32 v209, v209, v211
  v_mul_f32 v221, v221, v223
  v_cvt_pk_bf16_f32 v216, v208, v209
  v_mfma_f32_32x32x16_bf16 v[176:191], v[192:195], a[120:123], v[176:191]
  ds_read_b64_tr_b16 v[204:205], v22 offset:12288
  ds_read_b64_tr_b16 v[206:207], v22 offset:12800
  v_cvt_pk_bf16_f32 v228, v220, v221
  v_mul_f32 v212, v66, v66
  v_mul_f32 v224, v82, v82
  v_mul_f32 v213, v67, v67
  v_mul_f32 v225, v83, v83
  s_waitcnt lgkmcnt(4)
  v_mfma_f32_32x32x16_bf16 a[224:239], v[196:199], a[8:11], a[224:239]
  buffer_load_dwordx4 a[4:7], v250, s[20:23], s87 offen offset:2048 sc1
  v_fma_f32 v212, v212, s44, v25
  v_fma_f32 v224, v224, s44, v25
  v_fma_f32 v213, v213, s44, v25
  v_fma_f32 v225, v225, s44, v25
  v_mul_f32 v212, v212, v66
  v_mul_f32 v224, v224, v82
  v_mfma_f32_32x32x16_bf16 a[240:255], v[196:199], a[120:123], a[240:255]
  buffer_load_dwordx4 a[116:119], v251, s[20:23], s87 offen offset:2048 sc1
  v_mul_f32 v213, v213, v67
  v_mul_f32 v225, v225, v83
  v_exp_f32 v212, v212
  v_exp_f32 v224, v224
  s_waitcnt lgkmcnt(2)
  v_mfma_f32_32x32x16_bf16 v[160:175], v[200:203], a[12:15], v[160:175]
  ds_read_b64_tr_b16 v[192:193], v21 offset:16384
  ds_read_b64_tr_b16 v[194:195], v21 offset:16896
  v_mul_f32 v214, v66, v74
  v_mul_f32 v226, v82, v90
  v_exp_f32 v213, v213
  v_exp_f32 v225, v225
  v_mfma_f32_32x32x16_bf16 v[176:191], v[200:203], a[124:127], v[176:191]
  ds_read_b64_tr_b16 v[196:197], v22 offset:16384
  ds_read_b64_tr_b16 v[198:199], v22 offset:16896
  v_mul_f32 v215, v67, v75
  v_mul_f32 v227, v83, v91
  v_add_f32 v212, 1.0, v212
  v_add_f32 v224, 1.0, v224
  v_add_f32 v213, 1.0, v213
  s_waitcnt lgkmcnt(4)
  v_mfma_f32_32x32x16_bf16 a[224:239], v[204:207], a[12:15], a[224:239]
  s_mov_b32 s87, 4096
  buffer_load_dwordx4 a[8:11], v250, s[20:23], s87 offen offset:0 sc1
  v_add_f32 v225, 1.0, v225
  v_rcp_f32 v212, v212
  v_rcp_f32 v224, v224
  v_mfma_f32_32x32x16_bf16 a[240:255], v[204:207], a[124:127], a[240:255]
  buffer_load_dwordx4 a[120:123], v251, s[20:23], s87 offen offset:0 sc1
  s_waitcnt lgkmcnt(2)
  v_mfma_f32_32x32x16_bf16 v[160:175], v[192:195], a[16:19], v[160:175]
  ds_read_b64_tr_b16 v[200:201], v21 offset:20480
  ds_read_b64_tr_b16 v[202:203], v21 offset:20992
  buffer_load_dword v232, v32, s[20:23], 0 offen sc0 sc1
  v_rcp_f32 v213, v213
  v_rcp_f32 v225, v225
  v_mfma_f32_32x32x16_bf16 v[176:191], v[192:195], a[128:131], v[176:191]
  ds_read_b64_tr_b16 v[204:205], v22 offset:20480
  ds_read_b64_tr_b16 v[206:207], v22 offset:20992
  v_mul_f32 v212, v212, v214
  v_mul_f32 v224, v224, v226
  v_mul_f32 v213, v213, v215
  v_mul_f32 v225, v225, v227
  v_cvt_pk_bf16_f32 v217, v212, v213
  s_waitcnt lgkmcnt(4)
  v_mfma_f32_32x32x16_bf16 a[224:239], v[196:199], a[16:19], a[224:239]
  buffer_load_dwordx4 a[12:15], v250, s[20:23], s87 offen offset:2048 sc1
  v_cvt_pk_bf16_f32 v229, v224, v225
  v_mul_f32 v208, v68, v68
  v_mul_f32 v220, v84, v84
  v_mul_f32 v209, v69, v69
  v_mul_f32 v221, v85, v85
  v_fma_f32 v208, v208, s44, v25
  v_mfma_f32_32x32x16_bf16 a[240:255], v[196:199], a[128:131], a[240:255]
  buffer_load_dwordx4 a[124:127], v251, s[20:23], s87 offen offset:2048 sc1
  v_fma_f32 v220, v220, s44, v25
  v_fma_f32 v209, v209, s44, v25
  v_fma_f32 v221, v221, s44, v25
  v_mul_f32 v208, v208, v68
  v_mul_f32 v220, v220, v84
  v_mul_f32 v209, v209, v69
  s_waitcnt lgkmcnt(2)
  v_mfma_f32_32x32x16_bf16 v[160:175], v[200:203], a[20:23], v[160:175]
  ds_read_b64_tr_b16 v[192:193], v21 offset:24576
  ds_read_b64_tr_b16 v[194:195], v21 offset:25088
  v_mul_f32 v221, v221, v85
  v_exp_f32 v208, v208
  v_exp_f32 v220, v220
  v_mfma_f32_32x32x16_bf16 v[176:191], v[200:203], a[132:135], v[176:191]
  ds_read_b64_tr_b16 v[196:197], v22 offset:24576
  ds_read_b64_tr_b16 v[198:199], v22 offset:25088
  v_mul_f32 v210, v68, v76
  v_mul_f32 v222, v84, v92
  v_exp_f32 v209, v209
  v_exp_f32 v221, v221
  s_waitcnt lgkmcnt(4)
  v_mfma_f32_32x32x16_bf16 a[224:239], v[204:207], a[20:23], a[224:239]
  s_mov_b32 s87, 8192
  buffer_load_dwordx4 a[16:19], v250, s[20:23], s87 offen offset:0 sc1
  v_mul_f32 v211, v69, v77
  v_mul_f32 v223, v85, v93
  v_add_f32 v208, 1.0, v208
  v_add_f32 v220, 1.0, v220
  v_add_f32 v209, 1.0, v209
  v_mfma_f32_32x32x16_bf16 a[240:255], v[204:207], a[132:135], a[240:255]
  buffer_load_dwordx4 a[128:131], v251, s[20:23], s87 offen offset:0 sc1
  v_add_f32 v221, 1.0, v221
  v_rcp_f32 v208, v208
  v_rcp_f32 v220, v220
  v_rcp_f32 v209, v209
  s_waitcnt lgkmcnt(2)
  v_mfma_f32_32x32x16_bf16 v[160:175], v[192:195], a[24:27], v[160:175]
  ds_read_b64_tr_b16 v[200:201], v21 offset:28672
  ds_read_b64_tr_b16 v[202:203], v21 offset:29184
  v_rcp_f32 v221, v221
  v_mul_f32 v208, v208, v210
  v_mul_f32 v220, v220, v222
  v_mul_f32 v209, v209, v211
  v_mfma_f32_32x32x16_bf16 v[176:191], v[192:195], a[136:139], v[176:191]
  ds_read_b64_tr_b16 v[204:205], v22 offset:28672
  ds_read_b64_tr_b16 v[206:207], v22 offset:29184
  v_mul_f32 v221, v221, v223
  v_cvt_pk_bf16_f32 v218, v208, v209
  v_cvt_pk_bf16_f32 v230, v220, v221
  v_mul_f32 v212, v70, v70
  v_mul_f32 v224, v86, v86
  s_waitcnt lgkmcnt(4)
  v_mfma_f32_32x32x16_bf16 a[224:239], v[196:199], a[24:27], a[224:239]
  buffer_load_dwordx4 a[20:23], v250, s[20:23], s87 offen offset:2048 sc1
  v_mul_f32 v213, v71, v71
  v_mul_f32 v225, v87, v87
  v_fma_f32 v212, v212, s44, v25
  v_fma_f32 v224, v224, s44, v25
  v_fma_f32 v213, v213, s44, v25
  v_fma_f32 v225, v225, s44, v25
  v_mfma_f32_32x32x16_bf16 a[240:255], v[196:199], a[136:139], a[240:255]
  buffer_load_dwordx4 a[132:135], v251, s[20:23], s87 offen offset:2048 sc1
  v_mul_f32 v212, v212, v70
  v_mul_f32 v224, v224, v86
  v_mul_f32 v213, v213, v71
  v_mul_f32 v225, v225, v87
  v_exp_f32 v212, v212
  s_waitcnt vmcnt(13) lgkmcnt(0)
  s_waitcnt vmcnt(6)
  v_cmp_eq_u32 vcc, v33, v232
  s_nop 1
  s_or_b64 s[94:95], vcc, s[88:89]
  s_cmp_eq_u64 s[94:95], -1
  s_cbranch_scc1 L_gotE
  s_mov_b32 s46, 0
L_spinE:
  s_sleep 1
  buffer_load_dword v232, v32, s[20:23], 0 offen sc0 sc1
  s_waitcnt vmcnt(0)
  v_cmp_eq_u32 vcc, v33, v232
  s_nop 1
  s_or_b64 s[94:95], vcc, s[88:89]
  s_cmp_eq_u64 s[94:95], -1
  s_cbranch_scc1 L_gotE
  s_add_u32 s46, s46, 1
  s_cmp_lt_u32 s46, 0x40000
  s_cbranch_scc1 L_spinE
L_gotE:
  s_barrier
  v_mfma_f32_32x32x16_bf16 v[160:175], v[200:203], a[28:31], v[160:175]
  ds_read_b64_tr_b16 v[192:193], v21 offset:32768
  ds_read_b64_tr_b16 v[194:195], v21 offset:33280
  buffer_load_dwordx2 v[254:255], v31, s[24:27], 0 offen offset:3584 sc1
  v_exp_f32 v224, v224
  v_mul_f32 v214, v70, v78
  v_mfma_f32_32x32x16_bf16 v[176:191], v[200:203], a[140:143], v[176:191]
  ds_read_b64_tr_b16 v[196:197], v22 offset:32768
  ds_read_b64_tr_b16 v[198:199], v22 offset:33280
  buffer_load_dwordx2 v[4:5], v31, s[24:27], 0 offen offset:3328 sc1
  v_mul_f32 v226, v86, v94
  v_exp_f32 v213, v213
  v_mfma_f32_32x32x16_bf16 a[224:239], v[204:207], a[28:31], a[224:239]
  s_mov_b32 s87, 12288
  buffer_load_dwordx4 a[24:27], v250, s[20:23], s87 offen offset:0 sc1
  buffer_load_dwordx2 v[248:249], v31, s[24:27], 0 offen offset:3072 sc1
  v_exp_f32 v225, v225
  v_mul_f32 v215, v71, v79
  v_mfma_f32_32x32x16_bf16 a[240:255], v[204:207], a[140:143], a[240:255]
  buffer_load_dwordx4 a[136:139], v251, s[20:23], s87 offen offset:0 sc1
  buffer_load_dwordx2 v[246:247], v31, s[24:27], 0 offen offset:2816 sc1
  v_mul_f32 v227, v87, v95
  v_add_f32 v212, 1.0, v212
  v_add_f32 v224, 1.0, v224
  v_add_f32 v213, 1.0, v213
  s_waitcnt lgkmcnt(2)
  v_mfma_f32_32x32x16_bf16 v[160:175], v[192:195], a[32:35], v[160:175]
  ds_read_b64_tr_b16 v[200:201], v21 offset:36864
  ds_read_b64_tr_b16 v[202:203], v21 offset:37376
  buffer_load_dwordx2 v[244:245], v31, s[24:27], 0 offen offset:2560 sc1
  v_add_f32 v225, 1.0, v225
  v_rcp_f32 v212, v212
  v_mfma_f32_32x32x16_bf16 v[176:191], v[192:195], a[144:147], v[176:191]
  ds_read_b64_tr_b16 v[204:205], v22 offset:36864
  ds_read_b64_tr_b16 v[206:207], v22 offset:37376
  buffer_load_dwordx2 v[242:243], v31, s[24:27], 0 offen offset:2304 sc1
  v_rcp_f32 v224, v224
  v_rcp_f32 v213, v213
  s_waitcnt lgkmcnt(4)
  v_mfma_f32_32x32x16_bf16 a[224:239], v[196:199], a[32:35], a[224:239]
  buffer_load_dwordx4 a[28:31], v250, s[20:23], s87 offen offset:2048 sc1
  buffer_load_dwordx2 v[240:241], v31, s[24:27], 0 offen offset:2048 sc1
  v_rcp_f32 v225, v225
  v_mul_f32 v212, v212, v214
  v_mul_f32 v224, v224, v226
  v_mfma_f32_32x32x16_bf16 a[240:255], v[196:199], a[144:147], a[240:255]
  buffer_load_dwordx4 a[140:143], v251, s[20:23], s87 offen offset:2048 sc1
  buffer_load_dwordx2 v[238:239], v31, s[24:27], 0 offen offset:1792 sc1
  v_mul_f32 v213, v213, v215
  v_mul_f32 v225, v225, v227
  v_cvt_pk_bf16_f32 v219, v212, v213
  v_cvt_pk_bf16_f32 v231, v224, v225
  s_waitcnt lgkmcnt(2)
  v_mfma_f32_32x32x16_bf16 v[160:175], v[200:203], a[36:39], v[160:175]
  ds_read_b64_tr_b16 v[192:193], v21 offset:40960
  ds_read_b64_tr_b16 v[194:195], v21 offset:41472
  buffer_load_dwordx2 v[236:237], v31, s[24:27], 0 offen offset:1536 sc1
  buffer_store_dwordx4 v[216:219], v23, s[20:23], 0 offen offset:0 sc1
  buffer_store_dwordx4 v[228:231], v24, s[20:23], 0 offen offset:0 sc1
  v_mul_f32 v208, v96, v96
  v_mfma_f32_32x32x16_bf16 v[176:191], v[200:203], a[148:151], v[176:191]
  ds_read_b64_tr_b16 v[196:197], v22 offset:40960
  ds_read_b64_tr_b16 v[198:199], v22 offset:41472
  buffer_load_dwordx2 v[18:19], v31, s[24:27], 0 offen offset:1280 sc1
  v_mul_f32 v220, v112, v112
  v_mul_f32 v209, v97, v97
  v_mul_f32 v221, v113, v113
  s_waitcnt lgkmcnt(4)
  v_mfma_f32_32x32x16_bf16 a[224:239], v[204:207], a[36:39], a[224:239]
  s_mov_b32 s87, 16384
  buffer_load_dwordx4 a[32:35], v250, s[20:23], s87 offen offset:0 sc1
  buffer_load_dwordx2 v[16:17], v31, s[24:27], 0 offen offset:1024 sc1
  v_fma_f32 v208, v208, s44, v25
  v_fma_f32 v220, v220, s44, v25
  v_fma_f32 v209, v209, s44, v25
  v_mfma_f32_32x32x16_bf16 a[240:255], v[204:207], a[148:151], a[240:255]
  buffer_load_dwordx4 a[144:147], v251, s[20:23], s87 offen offset:0 sc1
  buffer_load_dwordx2 v[14:15], v31, s[24:27], 0 offen offset:768 sc1
  v_fma_f32 v221, v221, s44, v25
  v_mul_f32 v208, v208, v96
  v_mul_f32 v220, v220, v112
  v_mul_f32 v209, v209, v97
  s_waitcnt lgkmcnt(2)
  v_mfma_f32_32x32x16_bf16 v[160:175], v[192:195], a[40:43], v[160:175]
  ds_read_b64_tr_b16 v[200:201], v21 offset:45056
  ds_read_b64_tr_b16 v[202:203], v21 offset:45568
  buffer_load_dwordx2 v[12:13], v31, s[24:27], 0 offen offset:512 sc1
  v_mul_f32 v221, v221, v113
  v_exp_f32 v208, v208
  v_mfma_f32_32x32x16_bf16 v[176:191], v[192:195], a[152:155], v[176:191]
  ds_read_b64_tr_b16 v[204:205], v22 offset:45056
  ds_read_b64_tr_b16 v[206:207], v22 offset:45568
  buffer_load_dwordx2 v[10:11], v31, s[24:27], 0 offen offset:256 sc1
  v_exp_f32 v220, v220
  v_mul_f32 v210, v96, v104
  s_waitcnt lgkmcnt(4)
  v_mfma_f32_32x32x16_bf16 a[224:239], v[196:199], a[40:43], a[224:239]
  buffer_load_dwordx4 a[36:39], v250, s[20:23], s87 offen offset:2048 sc1
  buffer_load_dwordx2 v[2:3], v31, s[24:27], 0 offen offset:0 sc1
  v_mul_f32 v222, v112, v120
  v_exp_f32 v209, v209
  v_exp_f32 v221, v221
  v_mfma_f32_32x32x16_bf16 a[240:255], v[196:199], a[152:155], a[240:255]
  buffer_load_dwordx4 a[148:151], v251, s[20:23], s87 offen offset:2048 sc1
  v_mul_f32 v211, v97, v105
  v_mul_f32 v223, v113, v121
  v_add_f32 v208, 1.0, v208
  v_add_f32 v220, 1.0, v220
  v_add_f32 v209, 1.0, v209
  v_add_f32 v221, 1.0, v221
  s_waitcnt lgkmcnt(2)
  v_mfma_f32_32x32x16_bf16 v[160:175], v[200:203], a[44:47], v[160:175]
  ds_read_b64_tr_b16 v[192:193], v21 offset:49152
  ds_read_b64_tr_b16 v[194:195], v21 offset:49664
  v_rcp_f32 v208, v208
  v_rcp_f32 v220, v220
  v_rcp_f32 v209, v209
  v_mfma_f32_32x32x16_bf16 v[176:191], v[200:203], a[156:159], v[176:191]
  ds_read_b64_tr_b16 v[196:197], v22 offset:49152
  ds_read_b64_tr_b16 v[198:199], v22 offset:49664
  v_rcp_f32 v221, v221
  v_mul_f32 v208, v208, v210
  v_mul_f32 v220, v220, v222
  v_mul_f32 v209, v209, v211
  s_waitcnt lgkmcnt(4)
  v_mfma_f32_32x32x16_bf16 a[224:239], v[204:207], a[44:47], a[224:239]
  s_mov_b32 s87, 20480
  buffer_load_dwordx4 a[40:43], v250, s[20:23], s87 offen offset:0 sc1
  v_mul_f32 v221, v221, v223
  v_cvt_pk_bf16_f32 v216, v208, v209
  v_cvt_pk_bf16_f32 v228, v220, v221
  v_mul_f32 v212, v98, v98
  v_mul_f32 v224, v114, v114
  v_mfma_f32_32x32x16_bf16 a[240:255], v[204:207], a[156:159], a[240:255]
  buffer_load_dwordx4 a[152:155], v251, s[20:23], s87 offen offset:0 sc1
  v_mul_f32 v213, v99, v99
  v_mul_f32 v225, v115, v115
  v_fma_f32 v212, v212, s44, v25
  v_fma_f32 v224, v224, s44, v25
  v_fma_f32 v213, v213, s44, v25
  v_fma_f32 v225, v225, s44, v25
  s_waitcnt lgkmcnt(2)
  v_mfma_f32_32x32x16_bf16 v[160:175], v[192:195], a[48:51], v[160:175]
  ds_read_b64_tr_b16 v[200:201], v21 offset:53248
  ds_read_b64_tr_b16 v[202:203], v21 offset:53760
  v_mul_f32 v212, v212, v98
  v_mul_f32 v224, v224, v114
  v_mul_f32 v213, v213, v99
  v_mul_f32 v225, v225, v115
  v_exp_f32 v212, v212
  v_mfma_f32_32x32x16_bf16 v[176:191], v[192:195], a[160:163], v[176:191]
  ds_read_b64_tr_b16 v[204:205], v22 offset:53248
  ds_read_b64_tr_b16 v[206:207], v22 offset:53760
  v_exp_f32 v224, v224
  v_mul_f32 v214, v98, v106
  v_mul_f32 v226, v114, v122
  v_exp_f32 v213, v213
  s_waitcnt lgkmcnt(4)
  v_mfma_f32_32x32x16_bf16 a[224:239], v[196:199], a[48:51], a[224:239]
  buffer_load_dwordx4 a[44:47], v250, s[20:23], s87 offen offset:2048 sc1
  v_exp_f32 v225, v225
  v_mul_f32 v215, v99, v107
  v_mul_f32 v227, v115, v123
  v_add_f32 v212, 1.0, v212
  v_add_f32 v224, 1.0, v224
  v_mfma_f32_32x32x16_bf16 a[240:255], v[196:199], a[160:163], a[240:255]
  buffer_load_dwordx4 a[156:159], v251, s[20:23], s87 offen offset:2048 sc1
  v_add_f32 v213, 1.0, v213
  v_add_f32 v225, 1.0, v225
  v_rcp_f32 v212, v212
  v_rcp_f32 v224, v224
  s_waitcnt lgkmcnt(2)
  v_mfma_f32_32x32x16_bf16 v[160:175], v[200:203], a[52:55], v[160:175]
  ds_read_b64_tr_b16 v[192:193], v21 offset:57344
  ds_read_b64_tr_b16 v[194:195], v21 offset:57856
  v_rcp_f32 v213, v213
  v_rcp_f32 v225, v225
  v_mul_f32 v212, v212, v214
  v_mfma_f32_32x32x16_bf16 v[176:191], v[200:203], a[164:167], v[176:191]
  ds_read_b64_tr_b16 v[196:197], v22 offset:57344
  ds_read_b64_tr_b16 v[198:199], v22 offset:57856
  v_mul_f32 v224, v224, v226
  v_mul_f32 v213, v213, v215
  v_mul_f32 v225, v225, v227
  v_cvt_pk_bf16_f32 v217, v212, v213
  v_cvt_pk_bf16_f32 v229, v224, v225
  s_waitcnt lgkmcnt(4)
  v_mfma_f32_32x32x16_bf16 a[224:239], v[204:207], a[52:55], a[224:239]
  s_mov_b32 s87, 24576
  buffer_load_dwordx4 a[48:51], v250, s[20:23], s87 offen offset:0 sc1
  v_mul_f32 v208, v100, v100
  v_mul_f32 v220, v116, v116
  v_mul_f32 v209, v101, v101
  v_mul_f32 v221, v117, v117
  v_fma_f32 v208, v208, s44, v25
  v_mfma_f32_32x32x16_bf16 a[240:255], v[204:207], a[164:167], a[240:255]
  buffer_load_dwordx4 a[160:163], v251, s[20:23], s87 offen offset:0 sc1
  v_fma_f32 v220, v220, s44, v25
  v_fma_f32 v209, v209, s44, v25
  v_fma_f32 v221, v221, s44, v25
  v_mul_f32 v208, v208, v100
  v_mul_f32 v220, v220, v116
  v_mul_f32 v209, v209, v101
  s_waitcnt lgkmcnt(2)
  v_mfma_f32_32x32x16_bf16 v[160:175], v[192:195], a[56:59], v[160:175]
  ds_read_b64_tr_b16 v[200:201], v21 offset:61440
  ds_read_b64_tr_b16 v[202:203], v21 offset:61952
  v_mul_f32 v221, v221, v117
  v_exp_f32 v208, v208
  v_exp_f32 v220, v220
  v_mfma_f32_32x32x16_bf16 v[176:191], v[192:195], a[168:171], v[176:191]
  ds_read_b64_tr_b16 v[204:205], v22 offset:61440
  ds_read_b64_tr_b16 v[206:207], v22 offset:61952
  v_mul_f32 v210, v100, v108
  v_mul_f32 v222, v116, v124
  v_exp_f32 v209, v209
  v_exp_f32 v221, v221
  s_waitcnt lgkmcnt(4)
  v_mfma_f32_32x32x16_bf16 a[224:239], v[196:199], a[56:59], a[224:239]
  buffer_load_dwordx4 a[52:55], v250, s[20:23], s87 offen offset:2048 sc1
  v_mul_f32 v211, v101, v109
  v_mul_f32 v223, v117, v125
  v_add_f32 v208, 1.0, v208
  v_add_f32 v220, 1.0, v220
  v_add_f32 v209, 1.0, v209
  v_add_f32 v221, 1.0, v221
  v_mfma_f32_32x32x16_bf16 a[240:255], v[196:199], a[168:171], a[240:255]
  buffer_load_dwordx4 a[164:167], v251, s[20:23], s87 offen offset:2048 sc1
  v_rcp_f32 v208, v208
  v_rcp_f32 v220, v220
  v_rcp_f32 v209, v209
  s_waitcnt lgkmcnt(2)
  v_mfma_f32_32x32x16_bf16 v[160:175], v[200:203], a[60:63], v[160:175]
  v_add_u32 v21, 0x10000, v21
  v_add_u32 v22, 0x10000, v22
  ds_read_b64_tr_b16 v[192:193], v21 offset:0
  ds_read_b64_tr_b16 v[194:195], v21 offset:512
  v_rcp_f32 v221, v221
  v_mul_f32 v208, v208, v210
  v_mfma_f32_32x32x16_bf16 v[176:191], v[200:203], a[172:175], v[176:191]
  ds_read_b64_tr_b16 v[196:197], v22 offset:0
  ds_read_b64_tr_b16 v[198:199], v22 offset:512
  v_mul_f32 v220, v220, v222
  v_mul_f32 v209, v209, v211
  v_mul_f32 v221, v221, v223
  s_waitcnt vmcnt(31)
  v_fma_f32 v58, v38, v254, v4
  v_cvt_pk_bf16_f32 v218, v208, v209
  s_waitcnt lgkmcnt(4)
  v_mfma_f32_32x32x16_bf16 a[224:239], v[204:207], a[60:63], a[224:239]
  s_mov_b32 s87, 28672
  buffer_load_dwordx4 a[56:59], v250, s[20:23], s87 offen offset:0 sc1
  v_fma_f32 v59, v38, v255, v5
  v_fma_f32 v50, -v39, v255, v58
  v_fma_f32 v51, v39, v254, v59
  s_waitcnt vmcnt(30)
  v_fma_f32 v58, v38, v50, v248
  v_fma_f32 v59, v38, v51, v249
  v_mfma_f32_32x32x16_bf16 a[240:255], v[204:207], a[172:175], a[240:255]
  buffer_load_dwordx4 a[168:171], v251, s[20:23], s87 offen offset:0 sc1
  v_cvt_pk_bf16_f32 v230, v220, v221
  v_fma_f32 v48, -v39, v51, v58
  v_fma_f32 v49, v39, v50, v59
  s_waitcnt vmcnt(29)
  v_fma_f32 v58, v38, v48, v246
  v_fma_f32 v59, v38, v49, v247
  v_fma_f32 v50, -v39, v49, v58
  s_waitcnt lgkmcnt(2)
  v_mfma_f32_32x32x16_bf16 v[160:175], v[192:195], a[64:67], v[160:175]
  ds_read_b64_tr_b16 v[200:201], v21 offset:4096
  ds_read_b64_tr_b16 v[202:203], v21 offset:4608
  v_fma_f32 v51, v39, v48, v59
  v_mul_f32 v212, v102, v102
  s_waitcnt vmcnt(28)
  v_fma_f32 v58, v38, v50, v244
  v_fma_f32 v59, v38, v51, v245
  v_fma_f32 v48, -v39, v51, v58
  v_mfma_f32_32x32x16_bf16 v[176:191], v[192:195], a[176:179], v[176:191]
  ds_read_b64_tr_b16 v[204:205], v22 offset:4096
  ds_read_b64_tr_b16 v[206:207], v22 offset:4608
  v_fma_f32 v49, v39, v50, v59
  s_waitcnt vmcnt(27)
  v_fma_f32 v58, v38, v48, v242
  v_fma_f32 v59, v38, v49, v243
  v_mul_f32 v224, v118, v118
  v_fma_f32 v50, -v39, v49, v58
  s_waitcnt lgkmcnt(4)
  v_mfma_f32_32x32x16_bf16 a[224:239], v[196:199], a[64:67], a[224:239]
  buffer_load_dwordx4 a[60:63], v250, s[20:23], s87 offen offset:2048 sc1
  v_fma_f32 v51, v39, v48, v59
  s_waitcnt vmcnt(26)
  v_fma_f32 v58, v38, v50, v240
  v_fma_f32 v59, v38, v51, v241
  v_fma_f32 v48, -v39, v51, v58
  v_fma_f32 v49, v39, v50, v59
  v_mul_f32 v213, v103, v103
  v_mfma_f32_32x32x16_bf16 a[240:255], v[196:199], a[176:179], a[240:255]
  buffer_load_dwordx4 a[172:175], v251, s[20:23], s87 offen offset:2048 sc1
  s_waitcnt vmcnt(25)
  v_fma_f32 v58, v38, v48, v238
  v_fma_f32 v59, v38, v49, v239
  v_fma_f32 v50, -v39, v49, v58
  v_fma_f32 v51, v39, v48, v59
  s_waitcnt vmcnt(24)
  v_fma_f32 v58, v38, v50, v236
  v_fma_f32 v59, v38, v51, v237
  s_waitcnt lgkmcnt(2)
  v_mfma_f32_32x32x16_bf16 v[160:175], v[200:203], a[68:71], v[160:175]
  ds_read_b64_tr_b16 v[192:193], v21 offset:8192
  ds_read_b64_tr_b16 v[194:195], v21 offset:8704
  v_mul_f32 v225, v119, v119
  v_fma_f32 v48, -v39, v51, v58
  v_fma_f32 v49, v39, v50, v59
  s_waitcnt vmcnt(21)
  v_fma_f32 v58, v38, v48, v18
  v_fma_f32 v59, v38, v49, v19
  v_mfma_f32_32x32x16_bf16 v[176:191], v[200:203], a[180:183], v[176:191]
  ds_read_b64_tr_b16 v[196:197], v22 offset:8192
  ds_read_b64_tr_b16 v[198:199], v22 offset:8704
  v_fma_f32 v50, -v39, v49, v58
  v_fma_f32 v51, v39, v48, v59
  v_fma_f32 v212, v212, s44, v25
  s_waitcnt vmcnt(19)
  v_fma_f32 v58, v38, v50, v16
  v_fma_f32 v59, v38, v51, v17
  s_waitcnt lgkmcnt(4)
  v_mfma_f32_32x32x16_bf16 a[224:239], v[204:207], a[68:71], a[224:239]
  s_mov_b32 s87, 32768
  buffer_load_dwordx4 a[64:67], v250, s[20:23], s87 offen offset:0 sc1
  v_fma_f32 v48, -v39, v51, v58
  v_fma_f32 v49, v39, v50, v59
  s_waitcnt vmcnt(18)
  v_fma_f32 v58, v38, v48, v14
  v_fma_f32 v59, v38, v49, v15
  v_fma_f32 v224, v224, s44, v25
  v_mfma_f32_32x32x16_bf16 a[240:255], v[204:207], a[180:183], a[240:255]
  buffer_load_dwordx4 a[176:179], v251, s[20:23], s87 offen offset:0 sc1
  v_fma_f32 v50, -v39, v49, v58
  v_fma_f32 v51, v39, v48, v59
  s_waitcnt vmcnt(18)
  v_fma_f32 v58, v38, v50, v12
  v_fma_f32 v59, v38, v51, v13
  v_fma_f32 v48, -v39, v51, v58
  v_fma_f32 v49, v39, v50, v59
  s_waitcnt lgkmcnt(2)
  v_mfma_f32_32x32x16_bf16 v[160:175], v[192:195], a[72:75], v[160:175]
  ds_read_b64_tr_b16 v[200:201], v21 offset:12288
  ds_read_b64_tr_b16 v[202:203], v21 offset:12800
  v_fma_f32 v213, v213, s44, v25
  s_waitcnt vmcnt(17)
  v_fma_f32 v58, v38, v48, v10
  v_fma_f32 v59, v38, v49, v11
  v_fma_f32 v50, -v39, v49, v58
  v_fma_f32 v51, v39, v48, v59
  v_mfma_f32_32x32x16_bf16 v[176:191], v[192:195], a[184:187], v[176:191]
  ds_read_b64_tr_b16 v[204:205], v22 offset:12288
  ds_read_b64_tr_b16 v[206:207], v22 offset:12800
  s_waitcnt vmcnt(15)
  v_fma_f32 v58, v38, v50, v2
  v_fma_f32 v59, v38, v51, v3
  v_fma_f32 v225, v225, s44, v25
  v_fma_f32 v48, -v39, v51, v58
  v_fma_f32 v49, v39, v50, v59
  s_waitcnt lgkmcnt(4)
  v_mfma_f32_32x32x16_bf16 a[224:239], v[196:199], a[72:75], a[224:239]
  buffer_load_dwordx4 a[68:71], v250, s[20:23], s87 offen offset:2048 sc1
  v_fma_f32 v58, v40, v48, v44
  v_fma_f32 v59, v40, v49, v45
  v_fma_f32 v50, -v41, v49, v58
  v_mul_f32 v212, v212, v102
  v_fma_f32 v51, v41, v48, v59
  v_fma_f32 v58, v34, v50, v128
  v_mfma_f32_32x32x16_bf16 a[240:255], v[196:199], a[184:187], a[240:255]
  buffer_load_dwordx4 a[180:183], v251, s[20:23], s87 offen offset:2048 sc1
  v_fma_f32 v59, v34, v51, v144
  v_fma_f32 v128, -v35, v51, v58
  v_fma_f32 v144, v35, v50, v59
  v_fma_f32 v58, v34, v128, v129
  v_mul_f32 v224, v224, v118
  v_mul_f32 v62, v43, v144
  s_waitcnt lgkmcnt(2)
  v_mfma_f32_32x32x16_bf16 v[160:175], v[200:203], a[76:79], v[160:175]
  ds_read_b64_tr_b16 v[192:193], v21 offset:16384
  ds_read_b64_tr_b16 v[194:195], v21 offset:16896
  v_fma_f32 v59, v34, v144, v145
  v_mul_f32 v63, v43, v128
  v_fma_f32 v60, v42, v128, -v62
  v_fma_f32 v129, -v35, v144, v58
  v_fma_f32 v61, v42, v144, v63
  v_mfma_f32_32x32x16_bf16 v[176:191], v[200:203], a[188:191], v[176:191]
  ds_read_b64_tr_b16 v[196:197], v22 offset:16384
  ds_read_b64_tr_b16 v[198:199], v22 offset:16896
  v_mul_f32 v213, v213, v103
  v_fma_f32 v145, v35, v128, v59
  v_cvt_pk_bf16_f32 v232, v60, -v61
  ds_write_b32 v27, v232 offset:0
  v_fma_f32 v58, v34, v129, v130
  s_waitcnt lgkmcnt(5)
  v_mfma_f32_32x32x16_bf16 a[224:239], v[204:207], a[76:79], a[224:239]
  s_mov_b32 s87, 36864
  buffer_load_dwordx4 a[72:75], v250, s[20:23], s87 offen offset:0 sc1
  v_mul_f32 v62, v43, v145
  v_fma_f32 v59, v34, v145, v146
  v_mul_f32 v225, v225, v119
  v_mul_f32 v63, v43, v129
  v_fma_f32 v60, v42, v129, -v62
  v_mfma_f32_32x32x16_bf16 a[240:255], v[204:207], a[188:191], a[240:255]
  buffer_load_dwordx4 a[184:187], v251, s[20:23], s87 offen offset:0 sc1
  v_fma_f32 v130, -v35, v145, v58
  v_fma_f32 v61, v42, v145, v63
  v_fma_f32 v146, v35, v129, v59
  v_cvt_pk_bf16_f32 v233, v60, -v61
  v_exp_f32 v212, v212
  s_waitcnt lgkmcnt(3)
  v_mfma_f32_32x32x16_bf16 v[160:175], v[192:195], a[80:83], v[160:175]
  ds_read_b64_tr_b16 v[200:201], v21 offset:20480
  ds_read_b64_tr_b16 v[202:203], v21 offset:20992
  ds_write_b32 v27, v233 offset:144
  v_fma_f32 v58, v34, v130, v131
  v_mul_f32 v62, v43, v146
  v_fma_f32 v59, v34, v146, v147
  v_mul_f32 v63, v43, v130
  v_mfma_f32_32x32x16_bf16 v[176:191], v[192:195], a[192:195], v[176:191]
  ds_read_b64_tr_b16 v[204:205], v22 offset:20480
  ds_read_b64_tr_b16 v[206:207], v22 offset:20992
  v_fma_f32 v60, v42, v130, -v62
  v_exp_f32 v224, v224
  v_fma_f32 v131, -v35, v146, v58
  v_fma_f32 v61, v42, v146, v63
  s_waitcnt lgkmcnt(6)
  v_mfma_f32_32x32x16_bf16 a[224:239], v[196:199], a[80:83], a[224:239]
  buffer_load_dwordx4 a[76:79], v250, s[20:23], s87 offen offset:2048 sc1
  v_fma_f32 v147, v35, v130, v59
  v_cvt_pk_bf16_f32 v234, v60, -v61
  ds_write_b32 v27, v234 offset:288
  v_fma_f32 v58, v34, v131, v132
  v_mul_f32 v214, v102, v110
  v_mul_f32 v62, v43, v147
  v_mfma_f32_32x32x16_bf16 a[240:255], v[196:199], a[192:195], a[240:255]
  buffer_load_dwordx4 a[188:191], v251, s[20:23], s87 offen offset:2048 sc1
  v_fma_f32 v59, v34, v147, v148
  v_mul_f32 v63, v43, v131
  v_fma_f32 v60, v42, v131, -v62
  v_fma_f32 v132, -v35, v147, v58
  v_fma_f32 v61, v42, v147, v63
  v_mul_f32 v226, v118, v126
  s_waitcnt lgkmcnt(4)
  v_mfma_f32_32x32x16_bf16 v[160:175], v[200:203], a[84:87], v[160:175]
  ds_read_b64_tr_b16 v[192:193], v21 offset:24576
  ds_read_b64_tr_b16 v[194:195], v21 offset:25088
  v_fma_f32 v148, v35, v131, v59
  v_cvt_pk_bf16_f32 v235, v60, -v61
  ds_write_b32 v27, v235 offset:432
  v_fma_f32 v58, v34, v132, v133
  v_mul_f32 v62, v43, v148
  v_mfma_f32_32x32x16_bf16 v[176:191], v[200:203], a[196:199], v[176:191]
  ds_read_b64_tr_b16 v[196:197], v22 offset:24576
  ds_read_b64_tr_b16 v[198:199], v22 offset:25088
  v_fma_f32 v59, v34, v148, v149
  v_exp_f32 v213, v213
  v_mul_f32 v63, v43, v132
  v_fma_f32 v60, v42, v132, -v62
  s_waitcnt lgkmcnt(6)
  v_mfma_f32_32x32x16_bf16 a[224:239], v[204:207], a[84:87], a[224:239]
  s_mov_b32 s87, 40960
  buffer_load_dwordx4 a[80:83], v250, s[20:23], s87 offen offset:0 sc1
  v_fma_f32 v133, -v35, v148, v58
  v_fma_f32 v61, v42, v148, v63
  v_fma_f32 v149, v35, v132, v59
  v_cvt_pk_bf16_f32 v232, v60, -v61
  v_exp_f32 v225, v225
  v_mfma_f32_32x32x16_bf16 a[240:255], v[204:207], a[196:199], a[240:255]
  buffer_load_dwordx4 a[192:195], v251, s[20:23], s87 offen offset:0 sc1
  ds_write_b32 v27, v232 offset:1152
  v_fma_f32 v58, v34, v133, v134
  v_mul_f32 v62, v43, v149
  v_fma_f32 v59, v34, v149, v150
  v_mul_f32 v63, v43, v133
  v_mul_f32 v215, v103, v111
  s_waitcnt lgkmcnt(4)
  v_mfma_f32_32x32x16_bf16 v[160:175], v[192:195], a[88:91], v[160:175]
  ds_read_b64_tr_b16 v[200:201], v21 offset:28672
  ds_read_b64_tr_b16 v[202:203], v21 offset:29184
  v_fma_f32 v60, v42, v133, -v62
  v_fma_f32 v134, -v35, v149, v58
  v_fma_f32 v61, v42, v149, v63
  v_fma_f32 v150, v35, v133, v59
  v_cvt_pk_bf16_f32 v233, v60, -v61
  v_mfma_f32_32x32x16_bf16 v[176:191], v[192:195], a[200:203], v[176:191]
  ds_read_b64_tr_b16 v[204:205], v22 offset:28672
  ds_read_b64_tr_b16 v[206:207], v22 offset:29184
  ds_write_b32 v27, v233 offset:1296
  v_mul_f32 v227, v119, v127
  v_fma_f32 v58, v34, v134, v135
  v_mul_f32 v62, v43, v150
  v_fma_f32 v59, v34, v150, v151
  s_waitcnt lgkmcnt(6)
  v_mfma_f32_32x32x16_bf16 a[224:239], v[196:199], a[88:91], a[224:239]
  buffer_load_dwordx4 a[84:87], v250, s[20:23], s87 offen offset:2048 sc1
  v_mul_f32 v63, v43, v134
  v_fma_f32 v60, v42, v134, -v62
  v_fma_f32 v135, -v35, v150, v58
  v_add_f32 v212, 1.0, v212
  v_fma_f32 v61, v42, v150, v63
  v_fma_f32 v151, v35, v134, v59
  v_mfma_f32_32x32x16_bf16 a[240:255], v[196:199], a[200:203], a[240:255]
  buffer_load_dwordx4 a[196:199], v251, s[20:23], s87 offen offset:2048 sc1
  v_cvt_pk_bf16_f32 v234, v60, -v61
  ds_write_b32 v27, v234 offset:1440
  v_fma_f32 v58, v34, v135, v136
  v_mul_f32 v62, v43, v151
  v_add_f32 v224, 1.0, v224
  v_fma_f32 v59, v34, v151, v152
  s_waitcnt lgkmcnt(4)
  v_mfma_f32_32x32x16_bf16 v[160:175], v[200:203], a[92:95], v[160:175]
  ds_read_b64_tr_b16 v[192:193], v21 offset:32768
  ds_read_b64_tr_b16 v[194:195], v21 offset:33280
  v_mul_f32 v63, v43, v135
  v_fma_f32 v60, v42, v135, -v62
  v_fma_f32 v136, -v35, v151, v58
  v_fma_f32 v61, v42, v151, v63
  v_fma_f32 v152, v35, v135, v59
  v_mfma_f32_32x32x16_bf16 v[176:191], v[200:203], a[204:207], v[176:191]
  ds_read_b64_tr_b16 v[196:197], v22 offset:32768
  ds_read_b64_tr_b16 v[198:199], v22 offset:33280
  v_add_f32 v213, 1.0, v213
  v_cvt_pk_bf16_f32 v235, v60, -v61
  ds_write_b32 v27, v235 offset:1584
  v_fma_f32 v58, v34, v136, v137
  v_mul_f32 v62, v43, v152
  s_waitcnt lgkmcnt(7)
  v_mfma_f32_32x32x16_bf16 a[224:239], v[204:207], a[92:95], a[224:239]
  s_mov_b32 s87, 45056
  buffer_load_dwordx4 a[88:91], v250, s[20:23], s87 offen offset:0 sc1
  v_fma_f32 v59, v34, v152, v153
  v_mul_f32 v63, v43, v136
  v_add_f32 v225, 1.0, v225
  v_fma_f32 v60, v42, v136, -v62
  v_fma_f32 v137, -v35, v152, v58
  v_mfma_f32_32x32x16_bf16 a[240:255], v[204:207], a[204:207], a[240:255]
  buffer_load_dwordx4 a[200:203], v251, s[20:23], s87 offen offset:0 sc1
  v_fma_f32 v61, v42, v152, v63
  v_fma_f32 v153, v35, v136, v59
  v_cvt_pk_bf16_f32 v232, v60, -v61
  ds_write_b32 v27, v232 offset:2304
  v_rcp_f32 v212, v212
  s_waitcnt lgkmcnt(4)
  v_mfma_f32_32x32x16_bf16 v[160:175], v[192:195], a[96:99], v[160:175]
  ds_read_b64_tr_b16 v[200:201], v21 offset:36864
  ds_read_b64_tr_b16 v[202:203], v21 offset:37376
  v_fma_f32 v58, v34, v137, v138
  v_mul_f32 v62, v43, v153
  v_fma_f32 v59, v34, v153, v154
  v_mul_f32 v63, v43, v137
  v_fma_f32 v60, v42, v137, -v62
  v_mfma_f32_32x32x16_bf16 v[176:191], v[192:195], a[208:211], v[176:191]
  ds_read_b64_tr_b16 v[204:205], v22 offset:36864
  ds_read_b64_tr_b16 v[206:207], v22 offset:37376
  v_fma_f32 v138, -v35, v153, v58
  v_rcp_f32 v224, v224
  v_fma_f32 v61, v42, v153, v63
  v_fma_f32 v154, v35, v137, v59
  s_waitcnt lgkmcnt(6)
  v_mfma_f32_32x32x16_bf16 a[224:239], v[196:199], a[96:99], a[224:239]
  buffer_load_dwordx4 a[92:95], v250, s[20:23], s87 offen offset:2048 sc1
  v_cvt_pk_bf16_f32 v233, v60, -v61
  ds_write_b32 v27, v233 offset:2448
  v_fma_f32 v58, v34, v138, v139
  v_mul_f32 v62, v43, v154
  v_rcp_f32 v213, v213
  v_mfma_f32_32x32x16_bf16 a[240:255], v[196:199], a[208:211], a[240:255]
  buffer_load_dwordx4 a[204:207], v251, s[20:23], s87 offen offset:2048 sc1
  v_fma_f32 v59, v34, v154, v155
  v_mul_f32 v63, v43, v138
  v_fma_f32 v60, v42, v138, -v62
  v_fma_f32 v139, -v35, v154, v58
  v_fma_f32 v61, v42, v154, v63
  v_rcp_f32 v225, v225
  s_waitcnt lgkmcnt(3)
  v_mfma_f32_32x32x16_bf16 v[160:175], v[200:203], a[100:103], v[160:175]
  ds_read_b64_tr_b16 v[192:193], v21 offset:40960
  ds_read_b64_tr_b16 v[194:195], v21 offset:41472
  v_fma_f32 v155, v35, v138, v59
  v_cvt_pk_bf16_f32 v234, v60, -v61
  ds_write_b32 v27, v234 offset:2592
  v_fma_f32 v58, v34, v139, v140
  v_mul_f32 v62, v43, v155
  v_mfma_f32_32x32x16_bf16 v[176:191], v[200:203], a[212:215], v[176:191]
  ds_read_b64_tr_b16 v[196:197], v22 offset:40960
  ds_read_b64_tr_b16 v[198:199], v22 offset:41472
  v_fma_f32 v59, v34, v155, v156
  v_mul_f32 v212, v212, v214
  v_mul_f32 v63, v43, v139
  v_fma_f32 v60, v42, v139, -v62
  v_fma_f32 v140, -v35, v155, v58
  s_waitcnt lgkmcnt(6)
  v_mfma_f32_32x32x16_bf16 a[224:239], v[204:207], a[100:103], a[224:239]
  s_mov_b32 s87, 49152
  buffer_load_dwordx4 a[96:99], v250, s[20:23], s87 offen offset:0 sc1
  v_fma_f32 v61, v42, v155, v63
  v_fma_f32 v156, v35, v139, v59
  v_cvt_pk_bf16_f32 v235, v60, -v61
  v_mul_f32 v224, v224, v226
  ds_write_b32 v27, v235 offset:2736
  v_mfma_f32_32x32x16_bf16 a[240:255], v[204:207], a[212:215], a[240:255]
  buffer_load_dwordx4 a[208:211], v251, s[20:23], s87 offen offset:0 sc1
  v_fma_f32 v58, v34, v140, v141
  v_mul_f32 v62, v43, v156
  v_fma_f32 v59, v34, v156, v157
  v_mul_f32 v63, v43, v140
  v_fma_f32 v60, v42, v140, -v62
  v_mul_f32 v213, v213, v215
  s_waitcnt lgkmcnt(4)
  v_mfma_f32_32x32x16_bf16 v[160:175], v[192:195], a[104:107], v[160:175]
  ds_read_b64_tr_b16 v[200:201], v21 offset:45056
  ds_read_b64_tr_b16 v[202:203], v21 offset:45568
  v_fma_f32 v141, -v35, v156, v58
  v_fma_f32 v61, v42, v156, v63
  v_fma_f32 v157, v35, v140, v59
  v_cvt_pk_bf16_f32 v232, v60, -v61
  ds_write_b32 v27, v232 offset:3456
  v_mfma_f32_32x32x16_bf16 v[176:191], v[192:195], a[216:219], v[176:191]
  ds_read_b64_tr_b16 v[204:205], v22 offset:45056
  ds_read_b64_tr_b16 v[206:207], v22 offset:45568
  v_fma_f32 v58, v34, v141, v142
  v_mul_f32 v225, v225, v227
  v_mul_f32 v62, v43, v157
  v_fma_f32 v59, v34, v157, v158
  v_mul_f32 v63, v43, v141
  s_waitcnt lgkmcnt(6)
  v_mfma_f32_32x32x16_bf16 a[224:239], v[196:199], a[104:107], a[224:239]
  buffer_load_dwordx4 a[100:103], v250, s[20:23], s87 offen offset:2048 sc1
  v_fma_f32 v60, v42, v141, -v62
  v_fma_f32 v142, -v35, v157, v58
  v_fma_f32 v61, v42, v157, v63
  v_cvt_pk_bf16_f32 v219, v212, v213
  v_fma_f32 v158, v35, v141, v59
  v_cvt_pk_bf16_f32 v233, v60, -v61
  v_mfma_f32_32x32x16_bf16 a[240:255], v[196:199], a[216:219], a[240:255]
  buffer_load_dwordx4 a[212:215], v251, s[20:23], s87 offen offset:2048 sc1
  ds_write_b32 v27, v233 offset:3600
  v_fma_f32 v58, v34, v142, v143
  v_mul_f32 v62, v43, v158
  v_fma_f32 v59, v34, v158, v159
  v_cvt_pk_bf16_f32 v231, v224, v225
  v_mul_f32 v63, v43, v142
  s_waitcnt lgkmcnt(4)
  v_mfma_f32_32x32x16_bf16 v[160:175], v[200:203], a[108:111], v[160:175]
  v_fma_f32 v60, v42, v142, -v62
  v_fma_f32 v143, -v35, v158, v58
  v_fma_f32 v61, v42, v158, v63
  v_fma_f32 v159, v35, v142, v59
  v_cvt_pk_bf16_f32 v234, v60, -v61
  buffer_store_dwordx4 v[216:219], v23, s[20:23], 0 offen offset:1024 sc1
  ds_write_b32 v27, v234 offset:3744
  v_mfma_f32_32x32x16_bf16 v[176:191], v[200:203], a[220:223], v[176:191]
  v_mul_f32 v62, v43, v159
  v_mul_f32 v63, v43, v143
  v_fma_f32 v60, v42, v143, -v62
  v_fma_f32 v61, v42, v159, v63
  v_cvt_pk_bf16_f32 v235, v60, -v61
  buffer_store_dwordx4 v[228:231], v24, s[20:23], 0 offen offset:1024 sc1
  ds_write_b32 v27, v235 offset:3888
  s_waitcnt lgkmcnt(3)
  v_mfma_f32_32x32x16_bf16 a[224:239], v[204:207], a[108:111], a[224:239]
  s_mov_b32 s87, 53248
  buffer_load_dwordx4 a[104:107], v250, s[20:23], s87 offen offset:0 sc1
  ds_read_b128 v[128:131], v28 offset:0
  ds_read_b128 v[132:135], v28 offset:32
  ds_read_b128 v[136:139], v28 offset:64
  ds_read_b128 v[140:143], v28 offset:96
  v_mfma_f32_32x32x16_bf16 a[240:255], v[204:207], a[220:223], a[240:255]
  buffer_load_dwordx4 a[216:219], v251, s[20:23], s87 offen offset:0 sc1
  buffer_load_dwordx4 a[108:111], v250, s[20:23], s87 offen offset:2048 sc1
  buffer_load_dwordx4 a[220:223], v251, s[20:23], s87 offen offset:2048 sc1
  v_pk_mul_f32 v[208:209], v[160:161], v[160:161]
  v_pk_mul_f32 v[220:221], v[176:177], v[176:177]
  v_pk_fma_f32 v[208:209], v[208:209], s[44:45], v[56:57]
  v_pk_fma_f32 v[220:221], v[220:221], s[44:45], v[56:57]
  v_pk_mul_f32 v[208:209], v[208:209], v[160:161]
  v_pk_mul_f32 v[220:221], v[220:221], v[176:177]
  v_exp_f32 v208, v208
  v_exp_f32 v220, v220
  v_exp_f32 v209, v209
  v_exp_f32 v221, v221
  v_pk_mul_f32 v[210:211], v[160:161], v[168:169]
  v_pk_mul_f32 v[222:223], v[176:177], v[184:185]
  v_pk_add_f32 v[208:209], v[208:209], 1.0 op_sel_hi:[1,0]
  v_pk_add_f32 v[220:221], v[220:221], 1.0 op_sel_hi:[1,0]
  v_rcp_f32 v208, v208
  v_rcp_f32 v220, v220
  v_rcp_f32 v209, v209
  v_rcp_f32 v221, v221
  v_pk_mul_f32 v[208:209], v[208:209], v[210:211]
  v_pk_mul_f32 v[220:221], v[220:221], v[222:223]
  s_waitcnt lgkmcnt(3)
  buffer_store_dwordx4 v[128:131], v23, s[20:23], s85 offen offset:0 sc1
  s_waitcnt lgkmcnt(2)
  buffer_store_dwordx4 v[132:135], v23, s[20:23], s85 offen offset:1024 sc1
  s_waitcnt lgkmcnt(1)
  buffer_store_dwordx4 v[136:139], v23, s[20:23], s85 offen offset:2048 sc1
  s_waitcnt lgkmcnt(0)
  buffer_store_dwordx4 v[140:143], v23, s[20:23], s85 offen offset:3072 sc1
  v_cvt_pk_bf16_f32 v216, v208, v209
  v_cvt_pk_bf16_f32 v228, v220, v221
  v_pk_mul_f32 v[212:213], v[162:163], v[162:163]
  v_pk_mul_f32 v[224:225], v[178:179], v[178:179]
  v_pk_fma_f32 v[212:213], v[212:213], s[44:45], v[56:57]
  v_pk_fma_f32 v[224:225], v[224:225], s[44:45], v[56:57]
  v_pk_mul_f32 v[212:213], v[212:213], v[162:163]
  v_pk_mul_f32 v[224:225], v[224:225], v[178:179]
  v_exp_f32 v212, v212
  v_exp_f32 v224, v224
  v_exp_f32 v213, v213
  v_exp_f32 v225, v225
  v_pk_mul_f32 v[214:215], v[162:163], v[170:171]
  v_pk_mul_f32 v[226:227], v[178:179], v[186:187]
  v_pk_add_f32 v[212:213], v[212:213], 1.0 op_sel_hi:[1,0]
  v_pk_add_f32 v[224:225], v[224:225], 1.0 op_sel_hi:[1,0]
  v_rcp_f32 v212, v212
  v_rcp_f32 v224, v224
  v_rcp_f32 v213, v213
  v_rcp_f32 v225, v225
  v_pk_mul_f32 v[212:213], v[212:213], v[214:215]
  v_pk_mul_f32 v[224:225], v[224:225], v[226:227]
  v_cvt_pk_bf16_f32 v217, v212, v213
  v_cvt_pk_bf16_f32 v229, v224, v225
  v_pk_mul_f32 v[208:209], v[164:165], v[164:165]
  v_pk_mul_f32 v[220:221], v[180:181], v[180:181]
  v_pk_fma_f32 v[208:209], v[208:209], s[44:45], v[56:57]
  v_pk_fma_f32 v[220:221], v[220:221], s[44:45], v[56:57]
  v_pk_mul_f32 v[208:209], v[208:209], v[164:165]
  v_pk_mul_f32 v[220:221], v[220:221], v[180:181]
  v_exp_f32 v208, v208
  v_exp_f32 v220, v220
  v_exp_f32 v209, v209
  v_exp_f32 v221, v221
  v_pk_mul_f32 v[210:211], v[164:165], v[172:173]
  v_pk_mul_f32 v[222:223], v[180:181], v[188:189]
  v_pk_add_f32 v[208:209], v[208:209], 1.0 op_sel_hi:[1,0]
  v_pk_add_f32 v[220:221], v[220:221], 1.0 op_sel_hi:[1,0]
  v_rcp_f32 v208, v208
  v_rcp_f32 v220, v220
  v_rcp_f32 v209, v209
  v_rcp_f32 v221, v221
  v_pk_mul_f32 v[208:209], v[208:209], v[210:211]
  v_pk_mul_f32 v[220:221], v[220:221], v[222:223]
  v_cvt_pk_bf16_f32 v218, v208, v209
  v_cvt_pk_bf16_f32 v230, v220, v221
  v_pk_mul_f32 v[212:213], v[166:167], v[166:167]
  v_pk_mul_f32 v[224:225], v[182:183], v[182:183]
  v_pk_fma_f32 v[212:213], v[212:213], s[44:45], v[56:57]
  v_pk_fma_f32 v[224:225], v[224:225], s[44:45], v[56:57]
  v_pk_mul_f32 v[212:213], v[212:213], v[166:167]
  v_pk_mul_f32 v[224:225], v[224:225], v[182:183]
  v_exp_f32 v212, v212
  v_exp_f32 v224, v224
  v_exp_f32 v213, v213
  v_exp_f32 v225, v225
  v_pk_mul_f32 v[214:215], v[166:167], v[174:175]
  v_pk_mul_f32 v[226:227], v[182:183], v[190:191]
  v_pk_add_f32 v[212:213], v[212:213], 1.0 op_sel_hi:[1,0]
  v_pk_add_f32 v[224:225], v[224:225], 1.0 op_sel_hi:[1,0]
  v_rcp_f32 v212, v212
  v_rcp_f32 v224, v224
  v_rcp_f32 v213, v213
  v_rcp_f32 v225, v225
  v_pk_mul_f32 v[212:213], v[212:213], v[214:215]
  v_pk_mul_f32 v[224:225], v[224:225], v[226:227]
  v_cvt_pk_bf16_f32 v219, v212, v213
  v_cvt_pk_bf16_f32 v231, v224, v225
  buffer_store_dwordx4 v[216:219], v23, s[20:23], s86 offen offset:0 sc1
  buffer_store_dwordx4 v[228:231], v24, s[20:23], s86 offen offset:0 sc1
  v_accvgpr_read_b32 v64, a224
  v_accvgpr_read_b32 v80, a240
  v_accvgpr_read_b32 v65, a225
  v_accvgpr_read_b32 v81, a241
  v_accvgpr_read_b32 v66, a226
  v_accvgpr_read_b32 v82, a242
  v_accvgpr_read_b32 v67, a227
  v_accvgpr_read_b32 v83, a243
  v_accvgpr_read_b32 v68, a228
  v_accvgpr_read_b32 v84, a244
  v_accvgpr_read_b32 v69, a229
  v_accvgpr_read_b32 v85, a245
  v_accvgpr_read_b32 v70, a230
  v_accvgpr_read_b32 v86, a246
  v_accvgpr_read_b32 v71, a231
  v_accvgpr_read_b32 v87, a247
  v_accvgpr_read_b32 v72, a232
  v_accvgpr_read_b32 v88, a248
  v_accvgpr_read_b32 v73, a233
  v_accvgpr_read_b32 v89, a249
  v_accvgpr_read_b32 v74, a234
  v_accvgpr_read_b32 v90, a250
  v_accvgpr_read_b32 v75, a235
  v_accvgpr_read_b32 v91, a251
  v_accvgpr_read_b32 v76, a236
  v_accvgpr_read_b32 v92, a252
  v_accvgpr_read_b32 v77, a237
  v_accvgpr_read_b32 v93, a253
  v_accvgpr_read_b32 v78, a238
  v_accvgpr_read_b32 v94, a254
  v_accvgpr_read_b32 v79, a239
  v_accvgpr_read_b32 v95, a255
  v_pk_mul_f32 v[208:209], v[64:65], v[64:65]
  v_pk_mul_f32 v[220:221], v[80:81], v[80:81]
  v_pk_fma_f32 v[208:209], v[208:209], s[44:45], v[56:57]
  v_pk_fma_f32 v[220:221], v[220:221], s[44:45], v[56:57]
  v_pk_mul_f32 v[208:209], v[208:209], v[64:65]
  v_pk_mul_f32 v[220:221], v[220:221], v[80:81]
  v_exp_f32 v208, v208
  v_exp_f32 v220, v220
  v_exp_f32 v209, v209
  v_exp_f32 v221, v221
  v_pk_mul_f32 v[210:211], v[64:65], v[72:73]
  v_pk_mul_f32 v[222:223], v[80:81], v[88:89]
  v_pk_add_f32 v[208:209], v[208:209], 1.0 op_sel_hi:[1,0]
  v_pk_add_f32 v[220:221], v[220:221], 1.0 op_sel_hi:[1,0]
  v_rcp_f32 v208, v208
  v_rcp_f32 v220, v220
  v_rcp_f32 v209, v209
  v_rcp_f32 v221, v221
  v_pk_mul_f32 v[208:209], v[208:209], v[210:211]
  v_pk_mul_f32 v[220:221], v[220:221], v[222:223]
  v_cvt_pk_bf16_f32 v216, v208, v209
  v_cvt_pk_bf16_f32 v228, v220, v221
  v_pk_mul_f32 v[212:213], v[66:67], v[66:67]
  v_pk_mul_f32 v[224:225], v[82:83], v[82:83]
  v_pk_fma_f32 v[212:213], v[212:213], s[44:45], v[56:57]
  v_pk_fma_f32 v[224:225], v[224:225], s[44:45], v[56:57]
  v_pk_mul_f32 v[212:213], v[212:213], v[66:67]
  v_pk_mul_f32 v[224:225], v[224:225], v[82:83]
  v_exp_f32 v212, v212
  v_exp_f32 v224, v224
  v_exp_f32 v213, v213
  v_exp_f32 v225, v225
  v_pk_mul_f32 v[214:215], v[66:67], v[74:75]
  v_pk_mul_f32 v[226:227], v[82:83], v[90:91]
  v_pk_add_f32 v[212:213], v[212:213], 1.0 op_sel_hi:[1,0]
  v_pk_add_f32 v[224:225], v[224:225], 1.0 op_sel_hi:[1,0]
  v_rcp_f32 v212, v212
  v_rcp_f32 v224, v224
  v_rcp_f32 v213, v213
  v_rcp_f32 v225, v225
  v_pk_mul_f32 v[212:213], v[212:213], v[214:215]
  v_pk_mul_f32 v[224:225], v[224:225], v[226:227]
  v_cvt_pk_bf16_f32 v217, v212, v213
  v_cvt_pk_bf16_f32 v229, v224, v225
  v_pk_mul_f32 v[208:209], v[68:69], v[68:69]
  v_pk_mul_f32 v[220:221], v[84:85], v[84:85]
  v_pk_fma_f32 v[208:209], v[208:209], s[44:45], v[56:57]
  v_pk_fma_f32 v[220:221], v[220:221], s[44:45], v[56:57]
  v_pk_mul_f32 v[208:209], v[208:209], v[68:69]
  v_pk_mul_f32 v[220:221], v[220:221], v[84:85]
  v_exp_f32 v208, v208
  v_exp_f32 v220, v220
  v_exp_f32 v209, v209
  v_exp_f32 v221, v221
  v_pk_mul_f32 v[210:211], v[68:69], v[76:77]
  v_pk_mul_f32 v[222:223], v[84:85], v[92:93]
  v_pk_add_f32 v[208:209], v[208:209], 1.0 op_sel_hi:[1,0]
  v_pk_add_f32 v[220:221], v[220:221], 1.0 op_sel_hi:[1,0]
  v_rcp_f32 v208, v208
  v_rcp_f32 v220, v220
  v_rcp_f32 v209, v209
  v_rcp_f32 v221, v221
  v_pk_mul_f32 v[208:209], v[208:209], v[210:211]
  v_pk_mul_f32 v[220:221], v[220:221], v[222:223]
  v_cvt_pk_bf16_f32 v218, v208, v209
  v_cvt_pk_bf16_f32 v230, v220, v221
  v_pk_mul_f32 v[212:213], v[70:71], v[70:71]
  v_pk_mul_f32 v[224:225], v[86:87], v[86:87]
  v_pk_fma_f32 v[212:213], v[212:213], s[44:45], v[56:57]
  v_pk_fma_f32 v[224:225], v[224:225], s[44:45], v[56:57]
  v_pk_mul_f32 v[212:213], v[212:213], v[70:71]
  v_pk_mul_f32 v[224:225], v[224:225], v[86:87]
  v_exp_f32 v212, v212
  v_exp_f32 v224, v224
  v_exp_f32 v213, v213
  v_exp_f32 v225, v225
  v_pk_mul_f32 v[214:215], v[70:71], v[78:79]
  v_pk_mul_f32 v[226:227], v[86:87], v[94:95]
  v_pk_add_f32 v[212:213], v[212:213], 1.0 op_sel_hi:[1,0]
  v_pk_add_f32 v[224:225], v[224:225], 1.0 op_sel_hi:[1,0]
  v_rcp_f32 v212, v212
  v_rcp_f32 v224, v224
  v_rcp_f32 v213, v213
  v_rcp_f32 v225, v225
  v_pk_mul_f32 v[212:213], v[212:213], v[214:215]
  v_pk_mul_f32 v[224:225], v[224:225], v[226:227]
  v_cvt_pk_bf16_f32 v219, v212, v213
  v_cvt_pk_bf16_f32 v231, v224, v225
  buffer_store_dwordx4 v[216:219], v23, s[20:23], s86 offen offset:1024 sc1
  buffer_store_dwordx4 v[228:231], v24, s[20:23], s86 offen offset:1024 sc1
  s_lshl_b32 s46, s38, 7
  s_add_u32 s46, s46, 13494272
  v_min_u32 v7, 13, v0
  v_lshl_add_u32 v7, v7, 2, s46
  s_cmp_eq_u32 s40, 3
  s_cselect_b32 s47, s39, 64
  v_cmp_eq_u32 vcc, s47, v0
  v_mov_b32 v6, 2147483632
  s_nop 0
  v_cndmask_b32 v4, v6, v7, vcc
  v_add_u32 v8, 1024, v253
  v_cmp_gt_u32 vcc, 32, v0
  s_nop 1
  v_cndmask_b32 v7, v8, v7, vcc
  v_lshlrev_b32 v1, 4, v0
  v_mov_b32 v5, v33
  s_waitcnt vmcnt(0)
  s_barrier
  buffer_store_dword v5, v4, s[20:23], 0 offen sc0 sc1
  s_lshl_b32 s52, s43, 10
  s_lshr_b32 s82, s43, 1
  s_lshl_b32 s83, s82, 11
  s_lshl_b32 s82, s82, 10
  s_load_dwordx2 s[48:49], s[0:1], 0
  s_load_dwordx2 s[64:65], s[0:1], 64
  s_load_dwordx2 s[76:77], s[0:1], 112
  s_cmp_ge_u32 s39, 7
  s_cselect_b32 s43, 2, 0
  s_lshl_b32 s44, s38, 2
  s_add_u32 s43, s43, s44
  s_add_u32 s43, s43, s42
  s_mul_i32 s44, s43, 172032
  s_xor_b32 s45, s43, 1
  s_mul_i32 s45, s45, 172032
  s_mul_i32 s46, s40, 28672
  s_add_u32 s44, s44, s46
  s_add_u32 s45, s45, s46
  v_add_u32 v2, s44, v1
  v_add_u32 v3, s45, v1
  s_mul_i32 s47, s40, 14
  s_sub_u32 s47, 112, s47
  s_lshl_b32 s50, s47, 10
  s_lshl_b32 s51, s47, 11
  v_add_u32 v63, s46, v1
  s_mov_b32 s36, s46
  v_and_b32 v6, 3, v0
  v_bfe_u32 v8, v0, 2, 1
  v_lshl_add_u32 v6, v8, 4, v6
  v_bfe_u32 v8, v0, 3, 2
  v_lshl_add_u32 v6, v8, 2, v6
  s_lshl_b32 s44, s43, 5
  v_add_u32 v6, s44, v6
  v_lshlrev_b32 v13, 3, v6
  v_add_u32 v13, 13418496, v13
  v_xor_b32 v8, 256, v13
  s_lshl_b32 s44, s3, 6
  s_lshl_b32 s45, s41, 5
  s_add_u32 s44, s44, s45
  v_lshrrev_b32 v9, 5, v0
  v_lshl_add_u32 v9, v9, 2, s44
  v_lshlrev_b32 v10, 1, v9
  s_movk_i32 s45, 896
  v_mad_u32_u24 v11, v6, s45, v10
  v_lshlrev_b32 v12, 1, v11
  s_waitcnt lgkmcnt(0)
  s_and_b32 s44, s43, -2
  s_mul_i32 s44, s44, 172032
  s_mul_i32 s45, s3, 49152
  s_add_u32 s44, s44, s45
  s_mul_i32 s45, s40, 12288
  s_add_u32 s44, s44, s45
  v_lshl_add_u32 v9, v0, 6, s44
  s_mov_b32 s4, s48
  s_mov_b32 s5, s49
  s_mov_b32 s6, 1835008
  s_mov_b32 s7, 0x00020000
  s_mov_b32 s8, s64
  s_mov_b32 s9, s65
  s_mov_b32 s10, 896
  s_mov_b32 s11, 0x00020000
  s_mov_b32 s12, s76
  s_mov_b32 s13, s77
  s_mov_b32 s14, 3670016
  s_mov_b32 s15, 0x00020000
  buffer_load_dwordx2 v[192:193], v11, s[4:7], 0 offen offset:0
  buffer_load_dwordx2 v[200:201], v10, s[8:11], 0 offen offset:0
  buffer_load_dwordx2 v[194:195], v11, s[4:7], 0 offen offset:16
  buffer_load_dwordx2 v[202:203], v10, s[8:11], 0 offen offset:16
  buffer_load_dwordx2 v[196:197], v11, s[4:7], 0 offen offset:32
  buffer_load_dwordx2 v[204:205], v10, s[8:11], 0 offen offset:32
  buffer_load_dwordx2 v[198:199], v11, s[4:7], 0 offen offset:48
  buffer_load_dwordx2 v[206:207], v10, s[8:11], 0 offen offset:48
  s_mov_b32 s43, 0xffff0000
  s_waitcnt vmcnt(7)
  v_lshlrev_b32 v18, 16, v192
  v_and_b32 v192, s43, v192
  s_waitcnt vmcnt(6)
  v_lshlrev_b32 v19, 16, v200
  v_and_b32 v200, s43, v200
  v_mul_f32 v18, v18, v19
  v_mul_f32 v192, v192, v200
  v_cvt_pk_bf16_f32 v18, v18, v192
  v_lshlrev_b32 v208, 16, v18
  v_and_b32 v209, s43, v18
  v_lshlrev_b32 v18, 16, v193
  v_and_b32 v193, s43, v193
  v_lshlrev_b32 v19, 16, v201
  v_and_b32 v201, s43, v201
  v_mul_f32 v18, v18, v19
  v_mul_f32 v193, v193, v201
  v_cvt_pk_bf16_f32 v18, v18, v193
  v_lshlrev_b32 v210, 16, v18
  v_and_b32 v211, s43, v18
  s_waitcnt vmcnt(5)
  v_lshlrev_b32 v18, 16, v194
  v_and_b32 v194, s43, v194
  s_waitcnt vmcnt(4)
  v_lshlrev_b32 v19, 16, v202
  v_and_b32 v202, s43, v202
  v_mul_f32 v18, v18, v19
  v_mul_f32 v194, v194, v202
  v_cvt_pk_bf16_f32 v18, v18, v194
  v_lshlrev_b32 v212, 16, v18
  v_and_b32 v213, s43, v18
  v_lshlrev_b32 v18, 16, v195
  v_and_b32 v195, s43, v195
  v_lshlrev_b32 v19, 16, v203
  v_and_b32 v203, s43, v203
  v_mul_f32 v18, v18, v19
  v_mul_f32 v195, v195, v203
  v_cvt_pk_bf16_f32 v18, v18, v195
  v_lshlrev_b32 v214, 16, v18
  v_and_b32 v215, s43, v18
  s_waitcnt vmcnt(3)
  v_lshlrev_b32 v18, 16, v196
  v_and_b32 v196, s43, v196
  s_waitcnt vmcnt(2)
  v_lshlrev_b32 v19, 16, v204
  v_and_b32 v204, s43, v204
  v_mul_f32 v18, v18, v19
  v_mul_f32 v196, v196, v204
  v_cvt_pk_bf16_f32 v18, v18, v196
  v_lshlrev_b32 v216, 16, v18
  v_and_b32 v217, s43, v18
  v_lshlrev_b32 v18, 16, v197
  v_and_b32 v197, s43, v197
  v_lshlrev_b32 v19, 16, v205
  v_and_b32 v205, s43, v205
  v_mul_f32 v18, v18, v19
  v_mul_f32 v197, v197, v205
  v_cvt_pk_bf16_f32 v18, v18, v197
  v_lshlrev_b32 v218, 16, v18
  v_and_b32 v219, s43, v18
  s_waitcnt vmcnt(1)
  v_lshlrev_b32 v18, 16, v198
  v_and_b32 v198, s43, v198
  s_waitcnt vmcnt(0)
  v_lshlrev_b32 v19, 16, v206
  v_and_b32 v206, s43, v206
  v_mul_f32 v18, v18, v19
  v_mul_f32 v198, v198, v206
  v_cvt_pk_bf16_f32 v18, v18, v198
  v_lshlrev_b32 v220, 16, v18
  v_and_b32 v221, s43, v18
  v_lshlrev_b32 v18, 16, v199
  v_and_b32 v199, s43, v199
  v_lshlrev_b32 v19, 16, v207
  v_and_b32 v207, s43, v207
  v_mul_f32 v18, v18, v19
  v_mul_f32 v199, v199, v207
  v_cvt_pk_bf16_f32 v18, v18, v199
  v_lshlrev_b32 v222, 16, v18
  v_and_b32 v223, s43, v18
  v_mov_b32 v128, v208
  v_mov_b32 v129, v209
  v_mov_b32 v130, v210
  v_mov_b32 v131, v211
  v_mov_b32 v132, v212
  v_mov_b32 v133, v213
  v_mov_b32 v134, v214
  v_mov_b32 v135, v215
  v_mov_b32 v136, v216
  v_mov_b32 v137, v217
  v_mov_b32 v138, v218
  v_mov_b32 v139, v219
  v_mov_b32 v140, v220
  v_mov_b32 v141, v221
  v_mov_b32 v142, v222
  v_mov_b32 v143, v223
  s_cmp_eq_u32 s40, 3
  s_cbranch_scc1 L_w0
  s_add_u32 s87, s51, s83
  s_add_u32 m0, s36, 0
  s_nop 0
  buffer_load_dwordx4 v250, s[20:23], s87 offen sc1 lds
  s_add_u32 m0, s36, 1024
  s_nop 0
  buffer_load_dwordx4 v251, s[20:23], s87 offen sc1 lds
  s_add_u32 s83, s83, 2048
  s_cmp_eq_u32 s83, 28672
  s_cselect_b32 s83, 0, s83
  s_add_u32 s87, s51, s83
  s_add_u32 m0, s36, 2048
  s_nop 0
  buffer_load_dwordx4 v250, s[20:23], s87 offen sc1 lds
  s_add_u32 m0, s36, 3072
  s_nop 0
  buffer_load_dwordx4 v251, s[20:23], s87 offen sc1 lds
  s_add_u32 s83, s83, 2048
  s_cmp_eq_u32 s83, 28672
  s_cselect_b32 s83, 0, s83
  s_add_u32 s87, s51, s83
  s_add_u32 m0, s36, 4096
  s_nop 0
  buffer_load_dwordx4 v250, s[20:23], s87 offen sc1 lds
  s_add_u32 m0, s36, 5120
  s_nop 0
  buffer_load_dwordx4 v251, s[20:23], s87 offen sc1 lds
  s_add_u32 s83, s83, 2048
  s_cmp_eq_u32 s83, 28672
  s_cselect_b32 s83, 0, s83
  s_add_u32 s87, s51, s83
  s_add_u32 m0, s36, 6144
  s_nop 0
  buffer_load_dwordx4 v250, s[20:23], s87 offen sc1 lds
  s_add_u32 m0, s36, 7168
  s_nop 0
  buffer_load_dwordx4 v251, s[20:23], s87 offen sc1 lds
  s_add_u32 s83, s83, 2048
  s_cmp_eq_u32 s83, 28672
  s_cselect_b32 s83, 0, s83
  s_add_u32 s87, s51, s83
  s_add_u32 m0, s36, 8192
  s_nop 0
  buffer_load_dwordx4 v250, s[20:23], s87 offen sc1 lds
  s_add_u32 m0, s36, 9216
  s_nop 0
  buffer_load_dwordx4 v251, s[20:23], s87 offen sc1 lds
  s_add_u32 s83, s83, 2048
  s_cmp_eq_u32 s83, 28672
  s_cselect_b32 s83, 0, s83
  s_add_u32 s87, s51, s83
  s_add_u32 m0, s36, 10240
  s_nop 0
  buffer_load_dwordx4 v250, s[20:23], s87 offen sc1 lds
  s_add_u32 m0, s36, 11264
  s_nop 0
  buffer_load_dwordx4 v251, s[20:23], s87 offen sc1 lds
  s_add_u32 s83, s83, 2048
  s_cmp_eq_u32 s83, 28672
  s_cselect_b32 s83, 0, s83
  s_add_u32 s87, s51, s83
  s_add_u32 m0, s36, 12288
  s_nop 0
  buffer_load_dwordx4 v250, s[20:23], s87 offen sc1 lds
  s_add_u32 m0, s36, 13312
  s_nop 0
  buffer_load_dwordx4 v251, s[20:23], s87 offen sc1 lds
  s_add_u32 s83, s83, 2048
  s_cmp_eq_u32 s83, 28672
  s_cselect_b32 s83, 0, s83
  s_add_u32 s87, s51, s83
  s_add_u32 m0, s36, 14336
  s_nop 0
  buffer_load_dwordx4 v250, s[20:23], s87 offen sc1 lds
  s_add_u32 m0, s36, 15360
  s_nop 0
  buffer_load_dwordx4 v251, s[20:23], s87 offen sc1 lds
  s_add_u32 s83, s83, 2048
  s_cmp_eq_u32 s83, 28672
  s_cselect_b32 s83, 0, s83
  s_add_u32 s87, s51, s83
  s_add_u32 m0, s36, 16384
  s_nop 0
  buffer_load_dwordx4 v250, s[20:23], s87 offen sc1 lds
  s_add_u32 m0, s36, 17408
  s_nop 0
  buffer_load_dwordx4 v251, s[20:23], s87 offen sc1 lds
  s_add_u32 s83, s83, 2048
  s_cmp_eq_u32 s83, 28672
  s_cselect_b32 s83, 0, s83
  s_add_u32 s87, s51, s83
  s_add_u32 m0, s36, 18432
  s_nop 0
  buffer_load_dwordx4 v250, s[20:23], s87 offen sc1 lds
  s_add_u32 m0, s36, 19456
  s_nop 0
  buffer_load_dwordx4 v251, s[20:23], s87 offen sc1 lds
  s_add_u32 s83, s83, 2048
  s_cmp_eq_u32 s83, 28672
  s_cselect_b32 s83, 0, s83
  s_add_u32 s87, s51, s83
  s_add_u32 m0, s36, 20480
  s_nop 0
  buffer_load_dwordx4 v250, s[20:23], s87 offen sc1 lds
  s_add_u32 m0, s36, 21504
  s_nop 0
  buffer_load_dwordx4 v251, s[20:23], s87 offen sc1 lds
  s_add_u32 s83, s83, 2048
  s_cmp_eq_u32 s83, 28672
  s_cselect_b32 s83, 0, s83
  s_add_u32 s87, s51, s83
  s_add_u32 m0, s36, 22528
  s_nop 0
  buffer_load_dwordx4 v250, s[20:23], s87 offen sc1 lds
  s_add_u32 m0, s36, 23552
  s_nop 0
  buffer_load_dwordx4 v251, s[20:23], s87 offen sc1 lds
  s_add_u32 s83, s83, 2048
  s_cmp_eq_u32 s83, 28672
  s_cselect_b32 s83, 0, s83
  s_add_u32 s87, s51, s83
  s_add_u32 m0, s36, 24576
  s_nop 0
  buffer_load_dwordx4 v250, s[20:23], s87 offen sc1 lds
  s_add_u32 m0, s36, 25600
  s_nop 0
  buffer_load_dwordx4 v251, s[20:23], s87 offen sc1 lds
  s_add_u32 s83, s83, 2048
  s_cmp_eq_u32 s83, 28672
  s_cselect_b32 s83, 0, s83
  s_add_u32 s87, s51, s83
  s_add_u32 m0, s36, 26624
  s_nop 0
  buffer_load_dwordx4 v250, s[20:23], s87 offen sc1 lds
  s_add_u32 m0, s36, 27648
  s_nop 0
  buffer_load_dwordx4 v251, s[20:23], s87 offen sc1 lds
  s_branch L_got2
L_w0:
  s_mov_b32 s46, 0
L_spin2:
  buffer_load_dword v4, v7, s[20:23], 0 offen sc0 sc1
  s_waitcnt vmcnt(0)
  v_cmp_eq_u32 vcc, v5, v4
  s_nop 1
  s_cmp_eq_u64 vcc, -1
  s_cbranch_scc1 L_got2
  s_sleep 1
  s_add_u32 s46, s46, 1
  s_cmp_lt_u32 s46, 0x40000
  s_cbranch_scc1 L_spin2
L_got2:
  s_barrier
  buffer_load_dwordx4 v[192:195], v2, s[20:23], s52 offen sc1
  buffer_load_dwordx4 v[196:199], v3, s[20:23], s52 offen sc1
  s_add_u32 s52, s52, 1024
  s_cmp_eq_u32 s52, 28672
  s_cselect_b32 s52, 0, s52
  buffer_load_dwordx4 v[200:203], v2, s[20:23], s52 offen sc1
  buffer_load_dwordx4 v[204:207], v3, s[20:23], s52 offen sc1
  s_add_u32 s52, s52, 1024
  s_cmp_eq_u32 s52, 28672
  s_cselect_b32 s52, 0, s52
  buffer_load_dwordx4 v[208:211], v2, s[20:23], s52 offen sc1
  buffer_load_dwordx4 v[212:215], v3, s[20:23], s52 offen sc1
  s_add_u32 s52, s52, 1024
  s_cmp_eq_u32 s52, 28672
  s_cselect_b32 s52, 0, s52
  buffer_load_dwordx4 v[216:219], v2, s[20:23], s52 offen sc1
  buffer_load_dwordx4 v[220:223], v3, s[20:23], s52 offen sc1
  s_add_u32 s52, s52, 1024
  s_cmp_eq_u32 s52, 28672
  s_cselect_b32 s52, 0, s52
  buffer_load_dwordx4 v[224:227], v2, s[20:23], s52 offen sc1
  buffer_load_dwordx4 v[228:231], v3, s[20:23], s52 offen sc1
  s_add_u32 s52, s52, 1024
  s_cmp_eq_u32 s52, 28672
  s_cselect_b32 s52, 0, s52
  buffer_load_dwordx4 v[232:235], v2, s[20:23], s52 offen sc1
  buffer_load_dwordx4 v[236:239], v3, s[20:23], s52 offen sc1
  s_add_u32 s52, s52, 1024
  s_cmp_eq_u32 s52, 28672
  s_cselect_b32 s52, 0, s52
  buffer_load_dwordx4 v[240:243], v2, s[20:23], s52 offen sc1
  buffer_load_dwordx4 v[244:247], v3, s[20:23], s52 offen sc1
  s_add_u32 s52, s52, 1024
  s_cmp_eq_u32 s52, 28672
  s_cselect_b32 s52, 0, s52
  buffer_load_dwordx4 v[20:23], v2, s[20:23], s52 offen sc1
  buffer_load_dwordx4 v[24:27], v3, s[20:23], s52 offen sc1
  s_add_u32 s52, s52, 1024
  s_cmp_eq_u32 s52, 28672
  s_cselect_b32 s52, 0, s52
  buffer_load_dwordx4 v[28:31], v2, s[20:23], s52 offen sc1
  buffer_load_dwordx4 v[32:35], v3, s[20:23], s52 offen sc1
  s_add_u32 s52, s52, 1024
  s_cmp_eq_u32 s52, 28672
  s_cselect_b32 s52, 0, s52
  buffer_load_dwordx4 v[36:39], v2, s[20:23], s52 offen sc1
  buffer_load_dwordx4 v[40:43], v3, s[20:23], s52 offen sc1
  s_add_u32 s52, s52, 1024
  s_cmp_eq_u32 s52, 28672
  s_cselect_b32 s52, 0, s52
  buffer_load_dwordx4 v[44:47], v2, s[20:23], s52 offen sc1
  buffer_load_dwordx4 v[48:51], v3, s[20:23], s52 offen sc1
  s_add_u32 s52, s52, 1024
  s_cmp_eq_u32 s52, 28672
  s_cselect_b32 s52, 0, s52
  buffer_load_dwordx4 v[52:55], v2, s[20:23], s52 offen sc1
  buffer_load_dwordx4 v[56:59], v3, s[20:23], s52 offen sc1
  buffer_load_dwordx2 v[14:15], v13, s[20:23], 0 offen sc1
  buffer_load_dwordx2 v[16:17], v8, s[20:23], 0 offen sc1
  s_waitcnt vmcnt(25)
  v_mfma_f32_32x32x16_bf16 v[64:79], a[0:3], v[192:195], 0
  v_mfma_f32_32x32x16_bf16 v[80:95], a[112:115], v[192:195], 0
  s_waitcnt vmcnt(24)
  v_mfma_f32_32x32x16_bf16 v[96:111], a[0:3], v[196:199], 0
  s_cmp_lg_u32 s40, 3
  s_cbranch_scc1 L_sk0
  s_add_u32 s87, s51, s83
  s_add_u32 m0, s36, 0
  s_nop 0
  buffer_load_dwordx4 v250, s[20:23], s87 offen sc1 lds
  s_add_u32 m0, s36, 1024
  s_nop 0
  buffer_load_dwordx4 v251, s[20:23], s87 offen sc1 lds
L_sk0:
  v_mfma_f32_32x32x16_bf16 v[112:127], a[112:115], v[196:199], 0
  s_waitcnt vmcnt(23)
  v_mfma_f32_32x32x16_bf16 v[64:79], a[4:7], v[200:203], v[64:79]
  s_add_u32 s52, s52, 1024
  s_cmp_eq_u32 s52, 28672
  s_cselect_b32 s52, 0, s52
  buffer_load_dwordx4 v[192:195], v2, s[20:23], s52 offen sc1
  buffer_load_dwordx4 v[196:199], v3, s[20:23], s52 offen sc1
  v_mfma_f32_32x32x16_bf16 v[80:95], a[116:119], v[200:203], v[80:95]
  s_waitcnt vmcnt(24)
  v_mfma_f32_32x32x16_bf16 v[96:111], a[4:7], v[204:207], v[96:111]
  s_cmp_lg_u32 s40, 3
  s_cbranch_scc1 L_sk1
  s_add_u32 s83, s83, 2048
  s_cmp_eq_u32 s83, 28672
  s_cselect_b32 s83, 0, s83
  s_add_u32 s87, s51, s83
  s_add_u32 m0, s36, 2048
  s_nop 0
  buffer_load_dwordx4 v250, s[20:23], s87 offen sc1 lds
  s_add_u32 m0, s36, 3072
  s_nop 0
  buffer_load_dwordx4 v251, s[20:23], s87 offen sc1 lds
L_sk1:
  v_mfma_f32_32x32x16_bf16 v[112:127], a[116:119], v[204:207], v[112:127]
  s_waitcnt vmcnt(23)
  v_mfma_f32_32x32x16_bf16 v[64:79], a[8:11], v[208:211], v[64:79]
  s_add_u32 s52, s52, 1024
  s_cmp_eq_u32 s52, 28672
  s_cselect_b32 s52, 0, s52
  buffer_load_dwordx4 v[200:203], v2, s[20:23], s52 offen sc1
  buffer_load_dwordx4 v[204:207], v3, s[20:23], s52 offen sc1
  v_mfma_f32_32x32x16_bf16 v[80:95], a[120:123], v[208:211], v[80:95]
  s_waitcnt vmcnt(24)
  v_mfma_f32_32x32x16_bf16 v[96:111], a[8:11], v[212:215], v[96:111]
  s_cmp_lg_u32 s40, 3
  s_cbranch_scc1 L_sk2
  s_add_u32 s83, s83, 2048
  s_cmp_eq_u32 s83, 28672
  s_cselect_b32 s83, 0, s83
  s_add_u32 s87, s51, s83
  s_add_u32 m0, s36, 4096
  s_nop 0
  buffer_load_dwordx4 v250, s[20:23], s87 offen sc1 lds
  s_add_u32 m0, s36, 5120
  s_nop 0
  buffer_load_dwordx4 v251, s[20:23], s87 offen sc1 lds
L_sk2:
  v_mfma_f32_32x32x16_bf16 v[112:127], a[120:123], v[212:215], v[112:127]
  s_waitcnt vmcnt(23)
  v_mfma_f32_32x32x16_bf16 v[64:79], a[12:15], v[216:219], v[64:79]
  s_add_u32 s52, s52, 1024
  s_cmp_eq_u32 s52, 28672
  s_cselect_b32 s52, 0, s52
  buffer_load_dwordx4 v[208:211], v2, s[20:23], s52 offen sc1
  buffer_load_dwordx4 v[212:215], v3, s[20:23], s52 offen sc1
  v_mfma_f32_32x32x16_bf16 v[80:95], a[124:127], v[216:219], v[80:95]
  s_waitcnt vmcnt(24)
  v_mfma_f32_32x32x16_bf16 v[96:111], a[12:15], v[220:223], v[96:111]
  s_cmp_lg_u32 s40, 3
  s_cbranch_scc1 L_sk3
  s_add_u32 s83, s83, 2048
  s_cmp_eq_u32 s83, 28672
  s_cselect_b32 s83, 0, s83
  s_add_u32 s87, s51, s83
  s_add_u32 m0, s36, 6144
  s_nop 0
  buffer_load_dwordx4 v250, s[20:23], s87 offen sc1 lds
  s_add_u32 m0, s36, 7168
  s_nop 0
  buffer_load_dwordx4 v251, s[20:23], s87 offen sc1 lds
L_sk3:
  v_mfma_f32_32x32x16_bf16 v[112:127], a[124:127], v[220:223], v[112:127]
  s_waitcnt vmcnt(23)
  v_mfma_f32_32x32x16_bf16 v[64:79], a[16:19], v[224:227], v[64:79]
  s_add_u32 s52, s52, 1024
  s_cmp_eq_u32 s52, 28672
  s_cselect_b32 s52, 0, s52
  buffer_load_dwordx4 v[216:219], v2, s[20:23], s52 offen sc1
  buffer_load_dwordx4 v[220:223], v3, s[20:23], s52 offen sc1
  v_mfma_f32_32x32x16_bf16 v[80:95], a[128:131], v[224:227], v[80:95]
  s_waitcnt vmcnt(24)
  v_mfma_f32_32x32x16_bf16 v[96:111], a[16:19], v[228:231], v[96:111]
  s_cmp_lg_u32 s40, 3
  s_cbranch_scc1 L_sk4
  s_add_u32 s83, s83, 2048
  s_cmp_eq_u32 s83, 28672
  s_cselect_b32 s83, 0, s83
  s_add_u32 s87, s51, s83
  s_add_u32 m0, s36, 8192
  s_nop 0
  buffer_load_dwordx4 v250, s[20:23], s87 offen sc1 lds
  s_add_u32 m0, s36, 9216
  s_nop 0
  buffer_load_dwordx4 v251, s[20:23], s87 offen sc1 lds
L_sk4:
  v_mfma_f32_32x32x16_bf16 v[112:127], a[128:131], v[228:231], v[112:127]
  s_waitcnt vmcnt(23)
  v_mfma_f32_32x32x16_bf16 v[64:79], a[20:23], v[232:235], v[64:79]
  s_add_u32 s52, s52, 1024
  s_cmp_eq_u32 s52, 28672
  s_cselect_b32 s52, 0, s52
  buffer_load_dwordx4 v[224:227], v2, s[20:23], s52 offen sc1
  buffer_load_dwordx4 v[228:231], v3, s[20:23], s52 offen sc1
  v_mfma_f32_32x32x16_bf16 v[80:95], a[132:135], v[232:235], v[80:95]
  s_waitcnt vmcnt(24)
  v_mfma_f32_32x32x16_bf16 v[96:111], a[20:23], v[236:239], v[96:111]
  s_cmp_lg_u32 s40, 3
  s_cbranch_scc1 L_sk5
  s_add_u32 s83, s83, 2048
  s_cmp_eq_u32 s83, 28672
  s_cselect_b32 s83, 0, s83
  s_add_u32 s87, s51, s83
  s_add_u32 m0, s36, 10240
  s_nop 0
  buffer_load_dwordx4 v250, s[20:23], s87 offen sc1 lds
  s_add_u32 m0, s36, 11264
  s_nop 0
  buffer_load_dwordx4 v251, s[20:23], s87 offen sc1 lds
L_sk5:
  v_mfma_f32_32x32x16_bf16 v[112:127], a[132:135], v[236:239], v[112:127]
  s_waitcnt vmcnt(23)
  v_mfma_f32_32x32x16_bf16 v[64:79], a[24:27], v[240:243], v[64:79]
  s_add_u32 s52, s52, 1024
  s_cmp_eq_u32 s52, 28672
  s_cselect_b32 s52, 0, s52
  buffer_load_dwordx4 v[232:235], v2, s[20:23], s52 offen sc1
  buffer_load_dwordx4 v[236:239], v3, s[20:23], s52 offen sc1
  v_mfma_f32_32x32x16_bf16 v[80:95], a[136:139], v[240:243], v[80:95]
  s_waitcnt vmcnt(24)
  v_mfma_f32_32x32x16_bf16 v[96:111], a[24:27], v[244:247], v[96:111]
  s_cmp_lg_u32 s40, 3
  s_cbranch_scc1 L_sk6
  s_add_u32 s83, s83, 2048
  s_cmp_eq_u32 s83, 28672
  s_cselect_b32 s83, 0, s83
  s_add_u32 s87, s51, s83
  s_add_u32 m0, s36, 12288
  s_nop 0
  buffer_load_dwordx4 v250, s[20:23], s87 offen sc1 lds
  s_add_u32 m0, s36, 13312
  s_nop 0
  buffer_load_dwordx4 v251, s[20:23], s87 offen sc1 lds
L_sk6:
  v_mfma_f32_32x32x16_bf16 v[112:127], a[136:139], v[244:247], v[112:127]
  s_waitcnt vmcnt(23)
  v_mfma_f32_32x32x16_bf16 v[64:79], a[28:31], v[20:23], v[64:79]
  s_add_u32 s52, s52, 1024
  s_cmp_eq_u32 s52, 28672
  s_cselect_b32 s52, 0, s52
  buffer_load_dwordx4 v[240:243], v2, s[20:23], s52 offen sc1
  buffer_load_dwordx4 v[244:247], v3, s[20:23], s52 offen sc1
  v_mfma_f32_32x32x16_bf16 v[80:95], a[140:143], v[20:23], v[80:95]
  s_waitcnt vmcnt(24)
  v_mfma_f32_32x32x16_bf16 v[96:111], a[28:31], v[24:27], v[96:111]
  s_cmp_lg_u32 s40, 3
  s_cbranch_scc1 L_sk7
  s_add_u32 s83, s83, 2048
  s_cmp_eq_u32 s83, 28672
  s_cselect_b32 s83, 0, s83
  s_add_u32 s87, s51, s83
  s_add_u32 m0, s36, 14336
  s_nop 0
  buffer_load_dwordx4 v250, s[20:23], s87 offen sc1 lds
  s_add_u32 m0, s36, 15360
  s_nop 0
  buffer_load_dwordx4 v251, s[20:23], s87 offen sc1 lds
L_sk7:
  v_mfma_f32_32x32x16_bf16 v[112:127], a[140:143], v[24:27], v[112:127]
  s_waitcnt vmcnt(23)
  v_mfma_f32_32x32x16_bf16 v[64:79], a[32:35], v[28:31], v[64:79]
  s_add_u32 s52, s52, 1024
  s_cmp_eq_u32 s52, 28672
  s_cselect_b32 s52, 0, s52
  buffer_load_dwordx4 v[20:23], v2, s[20:23], s52 offen sc1
  buffer_load_dwordx4 v[24:27], v3, s[20:23], s52 offen sc1
  v_mfma_f32_32x32x16_bf16 v[80:95], a[144:147], v[28:31], v[80:95]
  s_waitcnt vmcnt(24)
  v_mfma_f32_32x32x16_bf16 v[96:111], a[32:35], v[32:35], v[96:111]
  s_cmp_lg_u32 s40, 3
  s_cbranch_scc1 L_sk8
  s_add_u32 s83, s83, 2048
  s_cmp_eq_u32 s83, 28672
  s_cselect_b32 s83, 0, s83
  s_add_u32 s87, s51, s83
  s_add_u32 m0, s36, 16384
  s_nop 0
  buffer_load_dwordx4 v250, s[20:23], s87 offen sc1 lds
  s_add_u32 m0, s36, 17408
  s_nop 0
  buffer_load_dwordx4 v251, s[20:23], s87 offen sc1 lds
L_sk8:
  v_mfma_f32_32x32x16_bf16 v[112:127], a[144:147], v[32:35], v[112:127]
  s_waitcnt vmcnt(23)
  v_mfma_f32_32x32x16_bf16 v[64:79], a[36:39], v[36:39], v[64:79]
  s_add_u32 s52, s52, 1024
  s_cmp_eq_u32 s52, 28672
  s_cselect_b32 s52, 0, s52
  buffer_load_dwordx4 v[28:31], v2, s[20:23], s52 offen sc1
  buffer_load_dwordx4 v[32:35], v3, s[20:23], s52 offen sc1
  v_mfma_f32_32x32x16_bf16 v[80:95], a[148:151], v[36:39], v[80:95]
  s_waitcnt vmcnt(24)
  v_mfma_f32_32x32x16_bf16 v[96:111], a[36:39], v[40:43], v[96:111]
  s_cmp_lg_u32 s40, 3
  s_cbranch_scc1 L_sk9
  s_add_u32 s83, s83, 2048
  s_cmp_eq_u32 s83, 28672
  s_cselect_b32 s83, 0, s83
  s_add_u32 s87, s51, s83
  s_add_u32 m0, s36, 18432
  s_nop 0
  buffer_load_dwordx4 v250, s[20:23], s87 offen sc1 lds
  s_add_u32 m0, s36, 19456
  s_nop 0
  buffer_load_dwordx4 v251, s[20:23], s87 offen sc1 lds
L_sk9:
  v_mfma_f32_32x32x16_bf16 v[112:127], a[148:151], v[40:43], v[112:127]
  s_waitcnt vmcnt(23)
  v_mfma_f32_32x32x16_bf16 v[64:79], a[40:43], v[44:47], v[64:79]
  s_add_u32 s52, s52, 1024
  s_cmp_eq_u32 s52, 28672
  s_cselect_b32 s52, 0, s52
  buffer_load_dwordx4 v[36:39], v2, s[20:23], s52 offen sc1
  buffer_load_dwordx4 v[40:43], v3, s[20:23], s52 offen sc1
  v_mfma_f32_32x32x16_bf16 v[80:95], a[152:155], v[44:47], v[80:95]
  s_waitcnt vmcnt(24)
  v_mfma_f32_32x32x16_bf16 v[96:111], a[40:43], v[48:51], v[96:111]
  s_cmp_lg_u32 s40, 3
  s_cbranch_scc1 L_sk10
  s_add_u32 s83, s83, 2048
  s_cmp_eq_u32 s83, 28672
  s_cselect_b32 s83, 0, s83
  s_add_u32 s87, s51, s83
  s_add_u32 m0, s36, 20480
  s_nop 0
  buffer_load_dwordx4 v250, s[20:23], s87 offen sc1 lds
  s_add_u32 m0, s36, 21504
  s_nop 0
  buffer_load_dwordx4 v251, s[20:23], s87 offen sc1 lds
L_sk10:
  v_mfma_f32_32x32x16_bf16 v[112:127], a[152:155], v[48:51], v[112:127]
  s_waitcnt vmcnt(23)
  v_mfma_f32_32x32x16_bf16 v[64:79], a[44:47], v[52:55], v[64:79]
  s_add_u32 s52, s52, 1024
  s_cmp_eq_u32 s52, 28672
  s_cselect_b32 s52, 0, s52
  buffer_load_dwordx4 v[44:47], v2, s[20:23], s52 offen sc1
  buffer_load_dwordx4 v[48:51], v3, s[20:23], s52 offen sc1
  v_mfma_f32_32x32x16_bf16 v[80:95], a[156:159], v[52:55], v[80:95]
  s_waitcnt vmcnt(24)
  v_mfma_f32_32x32x16_bf16 v[96:111], a[44:47], v[56:59], v[96:111]
  s_cmp_lg_u32 s40, 3
  s_cbranch_scc1 L_sk11
  s_add_u32 s83, s83, 2048
  s_cmp_eq_u32 s83, 28672
  s_cselect_b32 s83, 0, s83
  s_add_u32 s87, s51, s83
  s_add_u32 m0, s36, 22528
  s_nop 0
  buffer_load_dwordx4 v250, s[20:23], s87 offen sc1 lds
  s_add_u32 m0, s36, 23552
  s_nop 0
  buffer_load_dwordx4 v251, s[20:23], s87 offen sc1 lds
L_sk11:
  v_mfma_f32_32x32x16_bf16 v[112:127], a[156:159], v[56:59], v[112:127]
  s_waitcnt vmcnt(21)
  v_mfma_f32_32x32x16_bf16 v[64:79], a[48:51], v[192:195], v[64:79]
  s_add_u32 s52, s52, 1024
  s_cmp_eq_u32 s52, 28672
  s_cselect_b32 s52, 0, s52
  buffer_load_dwordx4 v[52:55], v2, s[20:23], s52 offen sc1
  buffer_load_dwordx4 v[56:59], v3, s[20:23], s52 offen sc1
  v_mfma_f32_32x32x16_bf16 v[80:95], a[160:163], v[192:195], v[80:95]
  s_waitcnt vmcnt(22)
  v_mfma_f32_32x32x16_bf16 v[96:111], a[48:51], v[196:199], v[96:111]
  s_cmp_lg_u32 s40, 3
  s_cbranch_scc1 L_sk12
  s_add_u32 s83, s83, 2048
  s_cmp_eq_u32 s83, 28672
  s_cselect_b32 s83, 0, s83
  s_add_u32 s87, s51, s83
  s_add_u32 m0, s36, 24576
  s_nop 0
  buffer_load_dwordx4 v250, s[20:23], s87 offen sc1 lds
  s_add_u32 m0, s36, 25600
  s_nop 0
  buffer_load_dwordx4 v251, s[20:23], s87 offen sc1 lds
L_sk12:
  v_mfma_f32_32x32x16_bf16 v[112:127], a[160:163], v[196:199], v[112:127]
  s_waitcnt vmcnt(21)
  v_mfma_f32_32x32x16_bf16 v[64:79], a[52:55], v[200:203], v[64:79]
  s_add_u32 s52, s52, 1024
  s_cmp_eq_u32 s52, 28672
  s_cselect_b32 s52, 0, s52
  buffer_load_dwordx4 v[192:195], v2, s[20:23], s52 offen sc1
  buffer_load_dwordx4 v[196:199], v3, s[20:23], s52 offen sc1
  v_mfma_f32_32x32x16_bf16 v[80:95], a[164:167], v[200:203], v[80:95]
  s_waitcnt vmcnt(22)
  v_mfma_f32_32x32x16_bf16 v[96:111], a[52:55], v[204:207], v[96:111]
  s_cmp_lg_u32 s40, 3
  s_cbranch_scc1 L_sk13
  s_add_u32 s83, s83, 2048
  s_cmp_eq_u32 s83, 28672
  s_cselect_b32 s83, 0, s83
  s_add_u32 s87, s51, s83
  s_add_u32 m0, s36, 26624
  s_nop 0
  buffer_load_dwordx4 v250, s[20:23], s87 offen sc1 lds
  s_add_u32 m0, s36, 27648
  s_nop 0
  buffer_load_dwordx4 v251, s[20:23], s87 offen sc1 lds
L_sk13:
  v_mfma_f32_32x32x16_bf16 v[112:127], a[164:167], v[204:207], v[112:127]
  s_waitcnt vmcnt(21)
  v_mfma_f32_32x32x16_bf16 v[64:79], a[56:59], v[208:211], v[64:79]
  s_add_u32 s52, s52, 1024
  s_cmp_eq_u32 s52, 28672
  s_cselect_b32 s52, 0, s52
  buffer_load_dwordx4 v[200:203], v2, s[20:23], s52 offen sc1
  buffer_load_dwordx4 v[204:207], v3, s[20:23], s52 offen sc1
  v_mfma_f32_32x32x16_bf16 v[80:95], a[168:171], v[208:211], v[80:95]
  s_waitcnt vmcnt(22)
  v_mfma_f32_32x32x16_bf16 v[96:111], a[56:59], v[212:215], v[96:111]
  ds_read_b128 a[0:3], v63 offset:0
  ds_read_b128 a[112:115], v63 offset:1024
  v_mfma_f32_32x32x16_bf16 v[112:127], a[168:171], v[212:215], v[112:127]
  s_waitcnt vmcnt(21)
  v_mfma_f32_32x32x16_bf16 v[64:79], a[60:63], v[216:219], v[64:79]
  s_add_u32 s52, s52, 1024
  s_cmp_eq_u32 s52, 28672
  s_cselect_b32 s52, 0, s52
  buffer_load_dwordx4 v[208:211], v2, s[20:23], s52 offen sc1
  buffer_load_dwordx4 v[212:215], v3, s[20:23], s52 offen sc1
  v_mfma_f32_32x32x16_bf16 v[80:95], a[172:175], v[216:219], v[80:95]
  s_waitcnt vmcnt(22)
  v_mfma_f32_32x32x16_bf16 v[96:111], a[60:63], v[220:223], v[96:111]
  ds_read_b128 a[4:7], v63 offset:2048
  ds_read_b128 a[116:119], v63 offset:3072
  v_mfma_f32_32x32x16_bf16 v[112:127], a[172:175], v[220:223], v[112:127]
  s_waitcnt vmcnt(21)
  v_mfma_f32_32x32x16_bf16 v[64:79], a[64:67], v[224:227], v[64:79]
  s_add_u32 s52, s52, 1024
  s_cmp_eq_u32 s52, 28672
  s_cselect_b32 s52, 0, s52
  buffer_load_dwordx4 v[216:219], v2, s[20:23], s52 offen sc1
  buffer_load_dwordx4 v[220:223], v3, s[20:23], s52 offen sc1
  v_mfma_f32_32x32x16_bf16 v[80:95], a[176:179], v[224:227], v[80:95]
  s_waitcnt vmcnt(22)
  v_mfma_f32_32x32x16_bf16 v[96:111], a[64:67], v[228:231], v[96:111]
  ds_read_b128 a[8:11], v63 offset:4096
  ds_read_b128 a[120:123], v63 offset:5120
  v_mfma_f32_32x32x16_bf16 v[112:127], a[176:179], v[228:231], v[112:127]
  s_waitcnt vmcnt(21)
  v_mfma_f32_32x32x16_bf16 v[64:79], a[68:71], v[232:235], v[64:79]
  s_add_u32 s52, s50, s82
  buffer_load_dwordx4 v[224:227], v2, s[20:23], s52 offen sc1
  buffer_load_dwordx4 v[228:231], v3, s[20:23], s52 offen sc1
  v_mfma_f32_32x32x16_bf16 v[80:95], a[180:183], v[232:235], v[80:95]
  s_waitcnt vmcnt(22)
  v_mfma_f32_32x32x16_bf16 v[96:111], a[68:71], v[236:239], v[96:111]
  ds_read_b128 a[12:15], v63 offset:6144
  ds_read_b128 a[124:127], v63 offset:7168
  v_mfma_f32_32x32x16_bf16 v[112:127], a[180:183], v[236:239], v[112:127]
  s_waitcnt vmcnt(21)
  v_mfma_f32_32x32x16_bf16 v[64:79], a[72:75], v[240:243], v[64:79]
  s_add_u32 s82, s82, 1024
  s_cmp_eq_u32 s82, 14336
  s_cselect_b32 s82, 0, s82
  s_add_u32 s52, s50, s82
  buffer_load_dwordx4 v[232:235], v2, s[20:23], s52 offen sc1
  buffer_load_dwordx4 v[236:239], v3, s[20:23], s52 offen sc1
  v_mfma_f32_32x32x16_bf16 v[80:95], a[184:187], v[240:243], v[80:95]
  s_waitcnt vmcnt(22)
  v_mfma_f32_32x32x16_bf16 v[96:111], a[72:75], v[244:247], v[96:111]
  ds_read_b128 a[16:19], v63 offset:8192
  ds_read_b128 a[128:131], v63 offset:9216
  v_mfma_f32_32x32x16_bf16 v[112:127], a[184:187], v[244:247], v[112:127]
  s_waitcnt vmcnt(21)
  v_mfma_f32_32x32x16_bf16 v[64:79], a[76:79], v[20:23], v[64:79]
  s_add_u32 s82, s82, 1024
  s_cmp_eq_u32 s82, 14336
  s_cselect_b32 s82, 0, s82
  s_add_u32 s52, s50, s82
  buffer_load_dwordx4 v[240:243], v2, s[20:23], s52 offen sc1
  buffer_load_dwordx4 v[244:247], v3, s[20:23], s52 offen sc1
  v_mfma_f32_32x32x16_bf16 v[80:95], a[188:191], v[20:23], v[80:95]
  s_waitcnt vmcnt(22)
  v_mfma_f32_32x32x16_bf16 v[96:111], a[76:79], v[24:27], v[96:111]
  ds_read_b128 a[20:23], v63 offset:10240
  ds_read_b128 a[132:135], v63 offset:11264
  v_mfma_f32_32x32x16_bf16 v[112:127], a[188:191], v[24:27], v[112:127]
  s_waitcnt vmcnt(21)
  v_mfma_f32_32x32x16_bf16 v[64:79], a[80:83], v[28:31], v[64:79]
  s_add_u32 s82, s82, 1024
  s_cmp_eq_u32 s82, 14336
  s_cselect_b32 s82, 0, s82
  s_add_u32 s52, s50, s82
  buffer_load_dwordx4 v[20:23], v2, s[20:23], s52 offen sc1
  buffer_load_dwordx4 v[24:27], v3, s[20:23], s52 offen sc1
  v_mfma_f32_32x32x16_bf16 v[80:95], a[192:195], v[28:31], v[80:95]
  s_waitcnt vmcnt(22)
  v_mfma_f32_32x32x16_bf16 v[96:111], a[80:83], v[32:35], v[96:111]
  ds_read_b128 a[24:27], v63 offset:12288
  ds_read_b128 a[136:139], v63 offset:13312
  v_mfma_f32_32x32x16_bf16 v[112:127], a[192:195], v[32:35], v[112:127]
  s_waitcnt vmcnt(21)
  v_mfma_f32_32x32x16_bf16 v[64:79], a[84:87], v[36:39], v[64:79]
  s_add_u32 s82, s82, 1024
  s_cmp_eq_u32 s82, 14336
  s_cselect_b32 s82, 0, s82
  s_add_u32 s52, s50, s82
  buffer_load_dwordx4 v[28:31], v2, s[20:23], s52 offen sc1
  buffer_load_dwordx4 v[32:35], v3, s[20:23], s52 offen sc1
  v_mfma_f32_32x32x16_bf16 v[80:95], a[196:199], v[36:39], v[80:95]
  s_waitcnt vmcnt(22)
  v_mfma_f32_32x32x16_bf16 v[96:111], a[84:87], v[40:43], v[96:111]
  ds_read_b128 a[28:31], v63 offset:14336
  ds_read_b128 a[140:143], v63 offset:15360
  v_mfma_f32_32x32x16_bf16 v[112:127], a[196:199], v[40:43], v[112:127]
  s_waitcnt vmcnt(21)
  v_mfma_f32_32x32x16_bf16 v[64:79], a[88:91], v[44:47], v[64:79]
  s_add_u32 s82, s82, 1024
  s_cmp_eq_u32 s82, 14336
  s_cselect_b32 s82, 0, s82
  s_add_u32 s52, s50, s82
  buffer_load_dwordx4 v[36:39], v2, s[20:23], s52 offen sc1
  buffer_load_dwordx4 v[40:43], v3, s[20:23], s52 offen sc1
  v_mfma_f32_32x32x16_bf16 v[80:95], a[200:203], v[44:47], v[80:95]
  s_waitcnt vmcnt(22)
  v_mfma_f32_32x32x16_bf16 v[96:111], a[88:91], v[48:51], v[96:111]
  ds_read_b128 a[32:35], v63 offset:16384
  ds_read_b128 a[144:147], v63 offset:17408
  v_mfma_f32_32x32x16_bf16 v[112:127], a[200:203], v[48:51], v[112:127]
  s_waitcnt vmcnt(21)
  v_mfma_f32_32x32x16_bf16 v[64:79], a[92:95], v[52:55], v[64:79]
  s_add_u32 s82, s82, 1024
  s_cmp_eq_u32 s82, 14336
  s_cselect_b32 s82, 0, s82
  s_add_u32 s52, s50, s82
  buffer_load_dwordx4 v[44:47], v2, s[20:23], s52 offen sc1
  buffer_load_dwordx4 v[48:51], v3, s[20:23], s52 offen sc1
  v_mfma_f32_32x32x16_bf16 v[80:95], a[204:207], v[52:55], v[80:95]
  s_waitcnt vmcnt(22)
  v_mfma_f32_32x32x16_bf16 v[96:111], a[92:95], v[56:59], v[96:111]
  ds_read_b128 a[36:39], v63 offset:18432
  ds_read_b128 a[148:151], v63 offset:19456
  v_mfma_f32_32x32x16_bf16 v[112:127], a[204:207], v[56:59], v[112:127]
  s_waitcnt vmcnt(21)
  v_mfma_f32_32x32x16_bf16 v[64:79], a[96:99], v[192:195], v[64:79]
  s_add_u32 s82, s82, 1024
  s_cmp_eq_u32 s82, 14336
  s_cselect_b32 s82, 0, s82
  s_add_u32 s52, s50, s82
  buffer_load_dwordx4 v[52:55], v2, s[20:23], s52 offen sc1
  buffer_load_dwordx4 v[56:59], v3, s[20:23], s52 offen sc1
  v_mfma_f32_32x32x16_bf16 v[80:95], a[208:211], v[192:195], v[80:95]
  s_waitcnt vmcnt(22)
  v_mfma_f32_32x32x16_bf16 v[96:111], a[96:99], v[196:199], v[96:111]
  ds_read_b128 a[40:43], v63 offset:20480
  ds_read_b128 a[152:155], v63 offset:21504
  v_mfma_f32_32x32x16_bf16 v[112:127], a[208:211], v[196:199], v[112:127]
  s_waitcnt vmcnt(21)
  v_mfma_f32_32x32x16_bf16 v[64:79], a[100:103], v[200:203], v[64:79]
  s_add_u32 s82, s82, 1024
  s_cmp_eq_u32 s82, 14336
  s_cselect_b32 s82, 0, s82
  s_add_u32 s52, s50, s82
  buffer_load_dwordx4 v[192:195], v2, s[20:23], s52 offen sc1
  buffer_load_dwordx4 v[196:199], v3, s[20:23], s52 offen sc1
  v_mfma_f32_32x32x16_bf16 v[80:95], a[212:215], v[200:203], v[80:95]
  s_waitcnt vmcnt(22)
  v_mfma_f32_32x32x16_bf16 v[96:111], a[100:103], v[204:207], v[96:111]
  ds_read_b128 a[44:47], v63 offset:22528
  ds_read_b128 a[156:159], v63 offset:23552
  v_mfma_f32_32x32x16_bf16 v[112:127], a[212:215], v[204:207], v[112:127]
  s_waitcnt vmcnt(21)
  v_mfma_f32_32x32x16_bf16 v[64:79], a[104:107], v[208:211], v[64:79]
  s_add_u32 s82, s82, 1024
  s_cmp_eq_u32 s82, 14336
  s_cselect_b32 s82, 0, s82
  s_add_u32 s52, s50, s82
  buffer_load_dwordx4 v[200:203], v2, s[20:23], s52 offen sc1
  buffer_load_dwordx4 v[204:207], v3, s[20:23], s52 offen sc1
  v_mfma_f32_32x32x16_bf16 v[80:95], a[216:219], v[208:211], v[80:95]
  s_waitcnt vmcnt(22)
  v_mfma_f32_32x32x16_bf16 v[96:111], a[104:107], v[212:215], v[96:111]
  ds_read_b128 a[48:51], v63 offset:24576
  ds_read_b128 a[160:163], v63 offset:25600
  v_mfma_f32_32x32x16_bf16 v[112:127], a[216:219], v[212:215], v[112:127]
  s_waitcnt vmcnt(21)
  v_mfma_f32_32x32x16_bf16 v[64:79], a[108:111], v[216:219], v[64:79]
  s_add_u32 s82, s82, 1024
  s_cmp_eq_u32 s82, 14336
  s_cselect_b32 s82, 0, s82
  s_add_u32 s52, s50, s82
  buffer_load_dwordx4 v[208:211], v2, s[20:23], s52 offen sc1
  buffer_load_dwordx4 v[212:215], v3, s[20:23], s52 offen sc1
  v_mfma_f32_32x32x16_bf16 v[80:95], a[220:223], v[216:219], v[80:95]
  s_waitcnt vmcnt(22)
  v_mfma_f32_32x32x16_bf16 v[96:111], a[108:111], v[220:223], v[96:111]
  ds_read_b128 a[52:55], v63 offset:26624
  ds_read_b128 a[164:167], v63 offset:27648
  v_mfma_f32_32x32x16_bf16 v[112:127], a[220:223], v[220:223], v[112:127]
  s_waitcnt vmcnt(21) lgkmcnt(15)
  v_mfma_f32_32x32x16_bf16 v[128:143], a[0:3], v[224:227], v[128:143]
  s_add_u32 s82, s82, 1024
  s_cmp_eq_u32 s82, 14336
  s_cselect_b32 s82, 0, s82
  s_add_u32 s52, s50, s82
  buffer_load_dwordx4 v[216:219], v2, s[20:23], s52 offen sc1
  buffer_load_dwordx4 v[220:223], v3, s[20:23], s52 offen sc1
  v_mfma_f32_32x32x16_bf16 v[144:159], a[112:115], v[224:227], 0
  s_waitcnt vmcnt(22)
  v_mfma_f32_32x32x16_bf16 v[160:175], a[0:3], v[228:231], 0
  v_mfma_f32_32x32x16_bf16 v[176:191], a[112:115], v[228:231], 0
  s_waitcnt vmcnt(21)
  v_mfma_f32_32x32x16_bf16 v[128:143], a[4:7], v[232:235], v[128:143]
  s_add_u32 s82, s82, 1024
  s_cmp_eq_u32 s82, 14336
  s_cselect_b32 s82, 0, s82
  s_add_u32 s52, s50, s82
  buffer_load_dwordx4 v[224:227], v2, s[20:23], s52 offen sc1
  buffer_load_dwordx4 v[228:231], v3, s[20:23], s52 offen sc1
  v_mfma_f32_32x32x16_bf16 v[144:159], a[116:119], v[232:235], v[144:159]
  s_waitcnt vmcnt(22)
  v_mfma_f32_32x32x16_bf16 v[160:175], a[4:7], v[236:239], v[160:175]
  v_mfma_f32_32x32x16_bf16 v[176:191], a[116:119], v[236:239], v[176:191]
  s_waitcnt vmcnt(21)
  v_mfma_f32_32x32x16_bf16 v[128:143], a[8:11], v[240:243], v[128:143]
  s_add_u32 s82, s82, 1024
  s_cmp_eq_u32 s82, 14336
  s_cselect_b32 s82, 0, s82
  s_add_u32 s52, s50, s82
  buffer_load_dwordx4 v[232:235], v2, s[20:23], s52 offen sc1
  buffer_load_dwordx4 v[236:239], v3, s[20:23], s52 offen sc1
  v_mul_f32 v64, v64, v15
  v_mul_f32 v65, v65, v15
  v_mfma_f32_32x32x16_bf16 v[144:159], a[120:123], v[240:243], v[144:159]
  v_mul_f32 v66, v66, v15
  v_mul_f32 v67, v67, v15
  s_waitcnt vmcnt(22)
  v_mfma_f32_32x32x16_bf16 v[160:175], a[8:11], v[244:247], v[160:175]
  v_mul_f32 v68, v68, v15
  v_mul_f32 v69, v69, v15
  v_mfma_f32_32x32x16_bf16 v[176:191], a[120:123], v[244:247], v[176:191]
  v_mul_f32 v70, v70, v15
  v_mul_f32 v71, v71, v15
  s_waitcnt vmcnt(21)
  v_mfma_f32_32x32x16_bf16 v[128:143], a[12:15], v[20:23], v[128:143]
  v_mul_f32 v72, v72, v15
  v_mul_f32 v73, v73, v15
  v_mfma_f32_32x32x16_bf16 v[144:159], a[124:127], v[20:23], v[144:159]
  v_mul_f32 v74, v74, v15
  v_mul_f32 v75, v75, v15
  s_waitcnt vmcnt(20)
  v_mfma_f32_32x32x16_bf16 v[160:175], a[12:15], v[24:27], v[160:175]
  v_mul_f32 v76, v76, v15
  v_mul_f32 v77, v77, v15
  v_mfma_f32_32x32x16_bf16 v[176:191], a[124:127], v[24:27], v[176:191]
  v_mul_f32 v78, v78, v15
  v_mul_f32 v79, v79, v15
  s_waitcnt vmcnt(19)
  v_mfma_f32_32x32x16_bf16 v[128:143], a[16:19], v[28:31], v[128:143]
  v_mul_f32 v80, v80, v15
  v_mul_f32 v81, v81, v15
  v_mfma_f32_32x32x16_bf16 v[144:159], a[128:131], v[28:31], v[144:159]
  v_mul_f32 v82, v82, v15
  v_mul_f32 v83, v83, v15
  s_waitcnt vmcnt(18)
  v_mfma_f32_32x32x16_bf16 v[160:175], a[16:19], v[32:35], v[160:175]
  v_mul_f32 v84, v84, v15
  v_mul_f32 v85, v85, v15
  v_mfma_f32_32x32x16_bf16 v[176:191], a[128:131], v[32:35], v[176:191]
  v_mul_f32 v86, v86, v15
  v_mul_f32 v87, v87, v15
  s_waitcnt vmcnt(17)
  v_mfma_f32_32x32x16_bf16 v[128:143], a[20:23], v[36:39], v[128:143]
  v_mul_f32 v88, v88, v15
  v_mul_f32 v89, v89, v15
  v_mfma_f32_32x32x16_bf16 v[144:159], a[132:135], v[36:39], v[144:159]
  v_mul_f32 v90, v90, v15
  v_mul_f32 v91, v91, v15
  s_waitcnt vmcnt(16)
  v_mfma_f32_32x32x16_bf16 v[160:175], a[20:23], v[40:43], v[160:175]
  v_mul_f32 v92, v92, v15
  v_mul_f32 v93, v93, v15
  v_mfma_f32_32x32x16_bf16 v[176:191], a[132:135], v[40:43], v[176:191]
  v_mul_f32 v94, v94, v15
  v_mul_f32 v95, v95, v15
  s_waitcnt vmcnt(15)
  v_mfma_f32_32x32x16_bf16 v[128:143], a[24:27], v[44:47], v[128:143]
  v_mul_f32 v96, v96, v17
  v_mul_f32 v97, v97, v17
  s_waitcnt lgkmcnt(14)
  v_mfma_f32_32x32x16_bf16 v[144:159], a[136:139], v[44:47], v[144:159]
  v_mul_f32 v98, v98, v17
  v_mul_f32 v99, v99, v17
  s_waitcnt vmcnt(14)
  v_mfma_f32_32x32x16_bf16 v[160:175], a[24:27], v[48:51], v[160:175]
  v_mul_f32 v100, v100, v17
  v_mul_f32 v101, v101, v17
  v_mfma_f32_32x32x16_bf16 v[176:191], a[136:139], v[48:51], v[176:191]
  v_mul_f32 v102, v102, v17
  v_mul_f32 v103, v103, v17
  s_waitcnt vmcnt(13) lgkmcnt(13)
  v_mfma_f32_32x32x16_bf16 v[128:143], a[28:31], v[52:55], v[128:143]
  v_mul_f32 v104, v104, v17
  v_mul_f32 v105, v105, v17
  s_waitcnt lgkmcnt(12)
  v_mfma_f32_32x32x16_bf16 v[144:159], a[140:143], v[52:55], v[144:159]
  v_mul_f32 v106, v106, v17
  v_mul_f32 v107, v107, v17
  s_waitcnt vmcnt(12)
  v_mfma_f32_32x32x16_bf16 v[160:175], a[28:31], v[56:59], v[160:175]
  v_mul_f32 v108, v108, v17
  v_mul_f32 v109, v109, v17
  v_mfma_f32_32x32x16_bf16 v[176:191], a[140:143], v[56:59], v[176:191]
  v_mul_f32 v110, v110, v17
  v_mul_f32 v111, v111, v17
  s_waitcnt vmcnt(11) lgkmcnt(11)
  v_mfma_f32_32x32x16_bf16 v[128:143], a[32:35], v[192:195], v[128:143]
  v_mul_f32 v112, v112, v17
  v_mul_f32 v113, v113, v17
  s_waitcnt lgkmcnt(10)
  v_mfma_f32_32x32x16_bf16 v[144:159], a[144:147], v[192:195], v[144:159]
  v_mul_f32 v114, v114, v17
  v_mul_f32 v115, v115, v17
  s_waitcnt vmcnt(10)
  v_mfma_f32_32x32x16_bf16 v[160:175], a[32:35], v[196:199], v[160:175]
  v_mul_f32 v116, v116, v17
  v_mul_f32 v117, v117, v17
  v_mfma_f32_32x32x16_bf16 v[176:191], a[144:147], v[196:199], v[176:191]
  v_mul_f32 v118, v118, v17
  v_mul_f32 v119, v119, v17
  s_waitcnt vmcnt(9) lgkmcnt(9)
  v_mfma_f32_32x32x16_bf16 v[128:143], a[36:39], v[200:203], v[128:143]
  v_mul_f32 v120, v120, v17
  v_mul_f32 v121, v121, v17
  s_waitcnt lgkmcnt(8)
  v_mfma_f32_32x32x16_bf16 v[144:159], a[148:151], v[200:203], v[144:159]
  v_mul_f32 v122, v122, v17
  v_mul_f32 v123, v123, v17
  s_waitcnt vmcnt(8)
  v_mfma_f32_32x32x16_bf16 v[160:175], a[36:39], v[204:207], v[160:175]
  v_mul_f32 v124, v124, v17
  v_mul_f32 v125, v125, v17
  v_mfma_f32_32x32x16_bf16 v[176:191], a[148:151], v[204:207], v[176:191]
  v_mul_f32 v126, v126, v17
  v_mul_f32 v127, v127, v17
  s_waitcnt vmcnt(7) lgkmcnt(7)
  v_mfma_f32_32x32x16_bf16 v[128:143], a[40:43], v[208:211], v[128:143]
  s_waitcnt lgkmcnt(6)
  v_mfma_f32_32x32x16_bf16 v[144:159], a[152:155], v[208:211], v[144:159]
  s_waitcnt vmcnt(6)
  v_mfma_f32_32x32x16_bf16 v[160:175], a[40:43], v[212:215], v[160:175]
  v_mfma_f32_32x32x16_bf16 v[176:191], a[152:155], v[212:215], v[176:191]
  s_waitcnt vmcnt(5) lgkmcnt(5)
  v_mfma_f32_32x32x16_bf16 v[128:143], a[44:47], v[216:219], v[128:143]
  s_waitcnt lgkmcnt(4)
  v_mfma_f32_32x32x16_bf16 v[144:159], a[156:159], v[216:219], v[144:159]
  s_waitcnt vmcnt(4)
  v_mfma_f32_32x32x16_bf16 v[160:175], a[44:47], v[220:223], v[160:175]
  v_mfma_f32_32x32x16_bf16 v[176:191], a[156:159], v[220:223], v[176:191]
  s_waitcnt vmcnt(3) lgkmcnt(3)
  v_mfma_f32_32x32x16_bf16 v[128:143], a[48:51], v[224:227], v[128:143]
  s_waitcnt lgkmcnt(2)
  v_mfma_f32_32x32x16_bf16 v[144:159], a[160:163], v[224:227], v[144:159]
  s_waitcnt vmcnt(2)
  v_mfma_f32_32x32x16_bf16 v[160:175], a[48:51], v[228:231], v[160:175]
  v_mfma_f32_32x32x16_bf16 v[176:191], a[160:163], v[228:231], v[176:191]
  s_waitcnt vmcnt(1) lgkmcnt(1)
  v_mfma_f32_32x32x16_bf16 v[128:143], a[52:55], v[232:235], v[128:143]
  s_waitcnt lgkmcnt(0)
  v_mfma_f32_32x32x16_bf16 v[144:159], a[164:167], v[232:235], v[144:159]
  s_waitcnt vmcnt(0)
  v_mfma_f32_32x32x16_bf16 v[160:175], a[52:55], v[236:239], v[160:175]
  v_mfma_f32_32x32x16_bf16 v[176:191], a[164:167], v[236:239], v[176:191]
  s_xor_b32 s44, s40, 1
  s_mul_i32 s44, s44, 12288
  s_add_u32 s44, s44, 114688
  v_add_u32 v53, s44, v1
  s_xor_b32 s44, s40, 2
  s_mul_i32 s44, s44, 12288
  s_add_u32 s44, s44, 114688
  v_add_u32 v54, s44, v1
  s_xor_b32 s44, s40, 3
  s_mul_i32 s44, s44, 12288
  s_add_u32 s44, s44, 114688
  v_add_u32 v55, s44, v1
  s_mul_i32 s44, s40, 12288
  s_add_u32 s44, s44, 114688
  v_add_u32 v52, s44, v1
  v_pk_fma_f32 v[80:81], v[144:145], v[14:15], v[80:81] op_sel_hi:[1,0,1]
  v_pk_fma_f32 v[82:83], v[146:147], v[14:15], v[82:83] op_sel_hi:[1,0,1]
  ds_write_b128 v53, v[80:83] offset:0
  v_pk_fma_f32 v[84:85], v[148:149], v[14:15], v[84:85] op_sel_hi:[1,0,1]
  v_pk_fma_f32 v[86:87], v[150:151], v[14:15], v[86:87] op_sel_hi:[1,0,1]
  ds_write_b128 v53, v[84:87] offset:1024
  v_pk_fma_f32 v[88:89], v[152:153], v[14:15], v[88:89] op_sel_hi:[1,0,1]
  v_pk_fma_f32 v[90:91], v[154:155], v[14:15], v[90:91] op_sel_hi:[1,0,1]
  ds_write_b128 v53, v[88:91] offset:2048
  v_pk_fma_f32 v[92:93], v[156:157], v[14:15], v[92:93] op_sel_hi:[1,0,1]
  v_pk_fma_f32 v[94:95], v[158:159], v[14:15], v[94:95] op_sel_hi:[1,0,1]
  ds_write_b128 v53, v[92:95] offset:3072
  v_pk_fma_f32 v[96:97], v[160:161], v[16:17], v[96:97] op_sel_hi:[1,0,1]
  v_pk_fma_f32 v[98:99], v[162:163], v[16:17], v[98:99] op_sel_hi:[1,0,1]
  ds_write_b128 v54, v[96:99] offset:4096
  v_pk_fma_f32 v[100:101], v[164:165], v[16:17], v[100:101] op_sel_hi:[1,0,1]
  v_pk_fma_f32 v[102:103], v[166:167], v[16:17], v[102:103] op_sel_hi:[1,0,1]
  ds_write_b128 v54, v[100:103] offset:5120
  v_pk_fma_f32 v[104:105], v[168:169], v[16:17], v[104:105] op_sel_hi:[1,0,1]
  v_pk_fma_f32 v[106:107], v[170:171], v[16:17], v[106:107] op_sel_hi:[1,0,1]
  ds_write_b128 v54, v[104:107] offset:6144
  v_pk_fma_f32 v[108:109], v[172:173], v[16:17], v[108:109] op_sel_hi:[1,0,1]
  v_pk_fma_f32 v[110:111], v[174:175], v[16:17], v[110:111] op_sel_hi:[1,0,1]
  ds_write_b128 v54, v[108:111] offset:7168
  v_pk_fma_f32 v[112:113], v[176:177], v[16:17], v[112:113] op_sel_hi:[1,0,1]
  v_pk_fma_f32 v[114:115], v[178:179], v[16:17], v[114:115] op_sel_hi:[1,0,1]
  ds_write_b128 v55, v[112:115] offset:8192
  v_pk_fma_f32 v[116:117], v[180:181], v[16:17], v[116:117] op_sel_hi:[1,0,1]
  v_pk_fma_f32 v[118:119], v[182:183], v[16:17], v[118:119] op_sel_hi:[1,0,1]
  ds_write_b128 v55, v[116:119] offset:9216
  v_pk_fma_f32 v[120:121], v[184:185], v[16:17], v[120:121] op_sel_hi:[1,0,1]
  v_pk_fma_f32 v[122:123], v[186:187], v[16:17], v[122:123] op_sel_hi:[1,0,1]
  ds_write_b128 v55, v[120:123] offset:10240
  v_pk_fma_f32 v[124:125], v[188:189], v[16:17], v[124:125] op_sel_hi:[1,0,1]
  v_pk_fma_f32 v[126:127], v[190:191], v[16:17], v[126:127] op_sel_hi:[1,0,1]
  ds_write_b128 v55, v[124:127] offset:11264
  v_pk_fma_f32 v[64:65], v[128:129], v[14:15], v[64:65] op_sel_hi:[1,0,1]
  v_pk_fma_f32 v[66:67], v[130:131], v[14:15], v[66:67] op_sel_hi:[1,0,1]
  v_pk_fma_f32 v[68:69], v[132:133], v[14:15], v[68:69] op_sel_hi:[1,0,1]
  v_pk_fma_f32 v[70:71], v[134:135], v[14:15], v[70:71] op_sel_hi:[1,0,1]
  v_pk_fma_f32 v[72:73], v[136:137], v[14:15], v[72:73] op_sel_hi:[1,0,1]
  v_pk_fma_f32 v[74:75], v[138:139], v[14:15], v[74:75] op_sel_hi:[1,0,1]
  v_pk_fma_f32 v[76:77], v[140:141], v[14:15], v[76:77] op_sel_hi:[1,0,1]
  v_pk_fma_f32 v[78:79], v[142:143], v[14:15], v[78:79] op_sel_hi:[1,0,1]
  s_waitcnt lgkmcnt(0)
  s_barrier
  ds_read_b128 v[128:131], v52 offset:0
  ds_read_b128 v[144:147], v52 offset:4096
  ds_read_b128 v[160:163], v52 offset:8192
  ds_read_b128 v[132:135], v52 offset:1024
  ds_read_b128 v[148:151], v52 offset:5120
  ds_read_b128 v[164:167], v52 offset:9216
  ds_read_b128 v[136:139], v52 offset:2048
  ds_read_b128 v[152:155], v52 offset:6144
  ds_read_b128 v[168:171], v52 offset:10240
  ds_read_b128 v[140:143], v52 offset:3072
  ds_read_b128 v[156:159], v52 offset:7168
  ds_read_b128 v[172:175], v52 offset:11264
  s_waitcnt lgkmcnt(11)
  v_pk_add_f32 v[64:65], v[64:65], v[128:129]
  v_pk_add_f32 v[66:67], v[66:67], v[130:131]
  s_waitcnt lgkmcnt(10)
  v_pk_add_f32 v[64:65], v[64:65], v[144:145]
  v_pk_add_f32 v[66:67], v[66:67], v[146:147]
  s_waitcnt lgkmcnt(9)
  v_pk_add_f32 v[64:65], v[64:65], v[160:161]
  v_pk_add_f32 v[66:67], v[66:67], v[162:163]
  buffer_store_dwordx4 v[64:67], v12, s[12:15], 0 offen offset:0
  s_waitcnt lgkmcnt(8)
  v_pk_add_f32 v[68:69], v[68:69], v[132:133]
  v_pk_add_f32 v[70:71], v[70:71], v[134:135]
  s_waitcnt lgkmcnt(7)
  v_pk_add_f32 v[68:69], v[68:69], v[148:149]
  v_pk_add_f32 v[70:71], v[70:71], v[150:151]
  s_waitcnt lgkmcnt(6)
  v_pk_add_f32 v[68:69], v[68:69], v[164:165]
  v_pk_add_f32 v[70:71], v[70:71], v[166:167]
  buffer_store_dwordx4 v[68:71], v12, s[12:15], 0 offen offset:32
  s_waitcnt lgkmcnt(5)
  v_pk_add_f32 v[72:73], v[72:73], v[136:137]
  v_pk_add_f32 v[74:75], v[74:75], v[138:139]
  s_waitcnt lgkmcnt(4)
  v_pk_add_f32 v[72:73], v[72:73], v[152:153]
  v_pk_add_f32 v[74:75], v[74:75], v[154:155]
  s_waitcnt lgkmcnt(3)
  v_pk_add_f32 v[72:73], v[72:73], v[168:169]
  v_pk_add_f32 v[74:75], v[74:75], v[170:171]
  buffer_store_dwordx4 v[72:75], v12, s[12:15], 0 offen offset:64
  s_waitcnt lgkmcnt(2)
  v_pk_add_f32 v[76:77], v[76:77], v[140:141]
  v_pk_add_f32 v[78:79], v[78:79], v[142:143]
  s_waitcnt lgkmcnt(1)
  v_pk_add_f32 v[76:77], v[76:77], v[156:157]
  v_pk_add_f32 v[78:79], v[78:79], v[158:159]
  s_waitcnt lgkmcnt(0)
  v_pk_add_f32 v[76:77], v[76:77], v[172:173]
  v_pk_add_f32 v[78:79], v[78:79], v[174:175]
  buffer_store_dwordx4 v[76:79], v12, s[12:15], 0 offen offset:96
  s_endpgm
L1_prep:
  s_waitcnt lgkmcnt(0)
  s_sub_u32 s46, s46, 28
  s_lshl_b32 s46, s46, 3
  s_add_u32 s38, s46, s3
  v_lshrrev_b32 v60, 6, v0
  v_and_b32 v0, 63, v0
  v_readfirstlane_b32 s40, v60
  s_lshl_b32 s38, s38, 2
  s_add_u32 s38, s38, s40
  s_mov_b32 s4, s48
  s_mov_b32 s5, s49
  s_mov_b32 s6, 1835008
  s_mov_b32 s7, 0x00020000
  s_mov_b32 s8, s72
  s_mov_b32 s9, s73
  s_mov_b32 s10, 1605632
  s_mov_b32 s11, 0x00020000
  s_mov_b32 s12, s58
  s_mov_b32 s13, s59
  s_mov_b32 s14, 401408
  s_mov_b32 s15, 0x00020000
  s_mov_b32 s16, s60
  s_mov_b32 s17, s61
  s_mov_b32 s18, 401408
  s_mov_b32 s19, 0x00020000
  s_mov_b32 s20, s80
  s_mov_b32 s21, s81
  s_mov_b32 s22, 13500416
  s_mov_b32 s23, 0x00020000
  s_mov_b32 s24, s74
  s_mov_b32 s25, s75
  s_mov_b32 s26, 896
  s_mov_b32 s27, 0x00020000
  s_mov_b32 s28, s78
  s_mov_b32 s29, s79
  s_mov_b32 s30, 256
  s_mov_b32 s31, 0x00020000
  s_cmp_lg_u32 s38, 127
  s_cbranch_scc1 L_ntw
  v_mov_b32 v1, 13498368
  buffer_load_dword v2, v1, s[20:23], 0 offen sc0 sc1
  v_lshlrev_b32 v3, 7, v0
  s_waitcnt vmcnt(0)
  v_add_u32 v2, 1, v2
  v_max_u32 v2, 1, v2
  buffer_store_dword v2, v3, s[28:31], 0 offen sc0 sc1
  buffer_store_dword v2, v1, s[20:23], 0 offen sc0 sc1
  s_waitcnt vmcnt(0)
L_ntw:
  v_lshrrev_b32 v1, 2, v0
  v_and_b32 v2, 3, v0
  v_lshlrev_b32 v3, 4, v2
  s_lshl_b32 s41, s38, 4
  v_add_u32 v4, s41, v1
  s_movk_i32 s47, 896
  v_mad_u32_u24 v5, v4, s47, v3
  v_mov_b32 v6, 2147483632
  v_lshlrev_b32 v7, 4, v0
  s_mul_i32 s42, s38, 14336
  v_add_u32 v7, s42, v7
  s_mul_i32 s36, s40, 14336
  s_add_u32 m0, s36, 0
  s_movk_i32 s43, 0
  buffer_load_dwordx4 v7, s[8:11], s43 offen offset:0 lds
  buffer_load_dwordx4 v7, s[8:11], s43 offen offset:1024 lds
  buffer_load_dwordx4 v7, s[8:11], s43 offen offset:2048 lds
  buffer_load_dwordx4 v7, s[8:11], s43 offen offset:3072 lds
  s_add_u32 m0, s36, 4096
  s_movk_i32 s43, 4096
  buffer_load_dwordx4 v7, s[8:11], s43 offen offset:0 lds
  buffer_load_dwordx4 v7, s[8:11], s43 offen offset:1024 lds
  buffer_load_dwordx4 v7, s[8:11], s43 offen offset:2048 lds
  buffer_load_dwordx4 v7, s[8:11], s43 offen offset:3072 lds
  s_add_u32 m0, s36, 8192
  s_movk_i32 s43, 8192
  buffer_load_dwordx4 v7, s[8:11], s43 offen offset:0 lds
  buffer_load_dwordx4 v7, s[8:11], s43 offen offset:1024 lds
  buffer_load_dwordx4 v7, s[8:11], s43 offen offset:2048 lds
  buffer_load_dwordx4 v7, s[8:11], s43 offen offset:3072 lds
  s_add_u32 m0, s36, 12288
  s_movk_i32 s43, 12288
  buffer_load_dwordx4 v7, s[8:11], s43 offen offset:0 lds
  buffer_load_dwordx4 v7, s[8:11], s43 offen offset:1024 lds
  s_lshr_b32 s44, s38, 3
  s_and_b32 s45, s38, 7
  s_lshl_b32 s46, s45, 4
  v_add_u32 v8, s46, v1
  s_lshl_b32 s46, s44, 6
  v_add_u32 v9, s46, v3
  v_mad_u32_u24 v9, v8, s47, v9
  s_cmp_lt_u32 s38, 112
  s_cselect_b32 s46, 0, 1073741816
  v_add_u32 v9, s46, v9
  s_mov_b32 s43, 0
  buffer_load_dwordx4 v[192:195], v9, s[12:15], s43 offen
  buffer_load_dwordx4 v[196:199], v9, s[16:19], s43 offen
  s_mov_b32 s43, 114688
  buffer_load_dwordx4 v[200:203], v9, s[12:15], s43 offen
  buffer_load_dwordx4 v[204:207], v9, s[16:19], s43 offen
  s_mov_b32 s43, 229376
  buffer_load_dwordx4 v[208:211], v9, s[12:15], s43 offen
  buffer_load_dwordx4 v[212:215], v9, s[16:19], s43 offen
  s_mov_b32 s43, 344064
  buffer_load_dwordx4 v[216:219], v9, s[12:15], s43 offen
  buffer_load_dwordx4 v[220:223], v9, s[16:19], s43 offen
  s_mov_b32 s84, 0x05040100
  s_mov_b32 s85, 0x07060302
  v_lshrrev_b32 v10, 5, v0
  v_bfe_u32 v11, v0, 2, 2
  v_lshl_add_u32 v10, v10, 2, v11
  v_mul_u32_u24 v10, 896, v10
  v_bfe_u32 v11, v0, 4, 1
  v_lshl_add_u32 v10, v11, 5, v10
  v_lshl_add_u32 v10, v2, 3, v10
  v_add_u32 v10, s36, v10
  s_lshl_b32 s43, s38, 11
  s_add_u32 s43, s43, 11010048
  s_add_u32 s43, s43, s46
  v_lshl_add_u32 v11, v0, 4, s43
  s_waitcnt vmcnt(8)
  ds_read_b64_tr_b16 v[128:129], v10 offset:0
  ds_read_b64_tr_b16 v[130:131], v10 offset:7168
  ds_read_b64_tr_b16 v[132:133], v10 offset:64
  ds_read_b64_tr_b16 v[134:135], v10 offset:7232
  ds_read_b64_tr_b16 v[136:137], v10 offset:128
  ds_read_b64_tr_b16 v[138:139], v10 offset:7296
  ds_read_b64_tr_b16 v[140:141], v10 offset:192
  ds_read_b64_tr_b16 v[142:143], v10 offset:7360
  ds_read_b64_tr_b16 v[144:145], v10 offset:256
  ds_read_b64_tr_b16 v[146:147], v10 offset:7424
  ds_read_b64_tr_b16 v[148:149], v10 offset:320
  ds_read_b64_tr_b16 v[150:151], v10 offset:7488
  ds_read_b64_tr_b16 v[152:153], v10 offset:384
  ds_read_b64_tr_b16 v[154:155], v10 offset:7552
  ds_read_b64_tr_b16 v[156:157], v10 offset:448
  ds_read_b64_tr_b16 v[158:159], v10 offset:7616
  ds_read_b64_tr_b16 v[160:161], v10 offset:512
  ds_read_b64_tr_b16 v[162:163], v10 offset:7680
  ds_read_b64_tr_b16 v[164:165], v10 offset:576
  ds_read_b64_tr_b16 v[166:167], v10 offset:7744
  ds_read_b64_tr_b16 v[168:169], v10 offset:640
  ds_read_b64_tr_b16 v[170:171], v10 offset:7808
  ds_read_b64_tr_b16 v[172:173], v10 offset:704
  ds_read_b64_tr_b16 v[174:175], v10 offset:7872
  ds_read_b64_tr_b16 v[176:177], v10 offset:768
  ds_read_b64_tr_b16 v[178:179], v10 offset:7936
  ds_read_b64_tr_b16 v[180:181], v10 offset:832
  ds_read_b64_tr_b16 v[182:183], v10 offset:8000
  s_mov_b32 s43, 0
  s_waitcnt lgkmcnt(15)
  buffer_store_dwordx4 v[128:131], v11, s[20:23], s43 offen offset:0 sc1
  buffer_store_dwordx4 v[132:135], v11, s[20:23], s43 offen offset:1024 sc1
  s_mov_b32 s43, 344064
  buffer_store_dwordx4 v[136:139], v11, s[20:23], s43 offen offset:0 sc1
  buffer_store_dwordx4 v[140:143], v11, s[20:23], s43 offen offset:1024 sc1
  s_mov_b32 s43, 688128
  buffer_store_dwordx4 v[144:147], v11, s[20:23], s43 offen offset:0 sc1
  buffer_store_dwordx4 v[148:151], v11, s[20:23], s43 offen offset:1024 sc1
  s_mov_b32 s43, 1032192
  s_waitcnt lgkmcnt(14)
  buffer_store_dwordx4 v[152:155], v11, s[20:23], s43 offen offset:0 sc1
  s_waitcnt lgkmcnt(12)
  buffer_store_dwordx4 v[156:159], v11, s[20:23], s43 offen offset:1024 sc1
  s_mov_b32 s43, 1376256
  s_waitcnt lgkmcnt(10)
  buffer_store_dwordx4 v[160:163], v11, s[20:23], s43 offen offset:0 sc1
  s_waitcnt lgkmcnt(8)
  buffer_store_dwordx4 v[164:167], v11, s[20:23], s43 offen offset:1024 sc1
  s_mov_b32 s43, 1720320
  s_waitcnt lgkmcnt(6)
  buffer_store_dwordx4 v[168:171], v11, s[20:23], s43 offen offset:0 sc1
  s_waitcnt lgkmcnt(4)
  buffer_store_dwordx4 v[172:175], v11, s[20:23], s43 offen offset:1024 sc1
  s_mov_b32 s43, 2064384
  s_waitcnt lgkmcnt(2)
  buffer_store_dwordx4 v[176:179], v11, s[20:23], s43 offen offset:0 sc1
  s_waitcnt lgkmcnt(0)
  buffer_store_dwordx4 v[180:183], v11, s[20:23], s43 offen offset:1024 sc1
  v_lshrrev_b32 v11, 6, v8
  s_mov_b32 s43, 344064
  v_mul_lo_u32 v11, v11, s43
  v_bfe_u32 v12, v8, 5, 1
  v_lshl_add_u32 v11, v12, 10, v11
  v_and_b32 v12, 31, v8
  v_lshl_add_u32 v11, v12, 4, v11
  v_lshl_add_u32 v11, v2, 11, v11
  s_lshl_b32 s43, s44, 13
  s_add_u32 s43, s43, 11239424
  s_add_u32 s43, s43, s46
  v_add_u32 v11, s43, v11
  s_cmp_lt_u32 s45, 4
  s_mov_b32 s86, 2064384
  s_cselect_b32 s86, s86, 1073741816
  s_mov_b32 s43, 0
  s_waitcnt vmcnt(20)
  v_perm_b32 v224, v196, v192, s84
  v_perm_b32 v225, v196, v192, s85
  v_perm_b32 v226, v197, v193, s84
  v_perm_b32 v227, v197, v193, s85
  buffer_store_dwordx4 v[224:227], v11, s[20:23], s43 offen offset:0 sc1
  v_perm_b32 v228, v198, v194, s84
  v_perm_b32 v229, v198, v194, s85
  v_perm_b32 v230, v199, v195, s84
  v_perm_b32 v231, v199, v195, s85
  buffer_store_dwordx4 v[228:231], v11, s[20:23], s43 offen offset:512 sc1
  s_mov_b32 s43, 688128
  s_waitcnt vmcnt(20)
  v_perm_b32 v232, v204, v200, s84
  v_perm_b32 v233, v204, v200, s85
  v_perm_b32 v234, v205, v201, s84
  v_perm_b32 v235, v205, v201, s85
  buffer_store_dwordx4 v[232:235], v11, s[20:23], s43 offen offset:0 sc1
  v_perm_b32 v236, v206, v202, s84
  v_perm_b32 v237, v206, v202, s85
  v_perm_b32 v238, v207, v203, s84
  v_perm_b32 v239, v207, v203, s85
  buffer_store_dwordx4 v[236:239], v11, s[20:23], s43 offen offset:512 sc1
  s_mov_b32 s43, 1376256
  s_waitcnt vmcnt(20)
  v_perm_b32 v224, v212, v208, s84
  v_perm_b32 v225, v212, v208, s85
  v_perm_b32 v226, v213, v209, s84
  v_perm_b32 v227, v213, v209, s85
  buffer_store_dwordx4 v[224:227], v11, s[20:23], s43 offen offset:0 sc1
  v_perm_b32 v228, v214, v210, s84
  v_perm_b32 v229, v214, v210, s85
  v_perm_b32 v230, v215, v211, s84
  v_perm_b32 v231, v215, v211, s85
  buffer_store_dwordx4 v[228:231], v11, s[20:23], s43 offen offset:512 sc1
  s_mov_b32 s43, s86
  s_waitcnt vmcnt(20)
  v_perm_b32 v232, v220, v216, s84
  v_perm_b32 v233, v220, v216, s85
  v_perm_b32 v234, v221, v217, s84
  v_perm_b32 v235, v221, v217, s85
  buffer_store_dwordx4 v[232:235], v11, s[20:23], s43 offen offset:0 sc1
  v_perm_b32 v236, v222, v218, s84
  v_perm_b32 v237, v222, v218, s85
  v_perm_b32 v238, v223, v219, s84
  v_perm_b32 v239, v223, v219, s85
  buffer_store_dwordx4 v[236:239], v11, s[20:23], s43 offen offset:512 sc1
  s_and_b32 s46, s38, -4
  s_add_u32 s46, s46, 13496320
  v_lshl_add_u32 v8, v0, 7, s46
  s_cmp_eq_u32 s40, 0
  s_cselect_b32 s47, 8, 0
  v_cmp_gt_u32 vcc, s47, v0
  s_nop 1
  v_cndmask_b32 v8, v6, v8, vcc
  s_cbranch_scc0 L_got3
  v_and_b32 v12, 128, v6
  s_mov_b32 s46, 0
L_spin3:
  buffer_load_dword v9, v12, s[28:31], 0 offen sc0 sc1
  s_waitcnt vmcnt(0)
  v_cmp_ne_u32 vcc, 0, v9
  s_nop 1
  s_cmp_eq_u64 vcc, -1
  s_cbranch_scc1 L_got3
  s_sleep 2
  s_add_u32 s46, s46, 1
  s_cmp_lt_u32 s46, 0x40000
  s_cbranch_scc1 L_spin3
L_got3:
  s_waitcnt vmcnt(0)
  s_barrier
  buffer_store_dword v9, v8, s[20:23], 0 offen sc0 sc1
  buffer_load_dwordx4 v[16:19], v5, s[4:7], 0 offen offset:0
  buffer_load_dwordx4 v[72:75], v3, s[24:27], 0 offen offset:0
  buffer_load_dwordx4 v[20:23], v5, s[4:7], 0 offen offset:64
  buffer_load_dwordx4 v[76:79], v3, s[24:27], 0 offen offset:64
  buffer_load_dwordx4 v[24:27], v5, s[4:7], 0 offen offset:128
  buffer_load_dwordx4 v[80:83], v3, s[24:27], 0 offen offset:128
  buffer_load_dwordx4 v[28:31], v5, s[4:7], 0 offen offset:192
  buffer_load_dwordx4 v[84:87], v3, s[24:27], 0 offen offset:192
  buffer_load_dwordx4 v[32:35], v5, s[4:7], 0 offen offset:256
  buffer_load_dwordx4 v[88:91], v3, s[24:27], 0 offen offset:256
  buffer_load_dwordx4 v[36:39], v5, s[4:7], 0 offen offset:320
  buffer_load_dwordx4 v[92:95], v3, s[24:27], 0 offen offset:320
  buffer_load_dwordx4 v[40:43], v5, s[4:7], 0 offen offset:384
  buffer_load_dwordx4 v[96:99], v3, s[24:27], 0 offen offset:384
  buffer_load_dwordx4 v[44:47], v5, s[4:7], 0 offen offset:448
  buffer_load_dwordx4 v[100:103], v3, s[24:27], 0 offen offset:448
  buffer_load_dwordx4 v[48:51], v5, s[4:7], 0 offen offset:512
  buffer_load_dwordx4 v[104:107], v3, s[24:27], 0 offen offset:512
  buffer_load_dwordx4 v[52:55], v5, s[4:7], 0 offen offset:576
  buffer_load_dwordx4 v[108:111], v3, s[24:27], 0 offen offset:576
  buffer_load_dwordx4 v[56:59], v5, s[4:7], 0 offen offset:640
  buffer_load_dwordx4 v[112:115], v3, s[24:27], 0 offen offset:640
  buffer_load_dwordx4 v[60:63], v5, s[4:7], 0 offen offset:704
  buffer_load_dwordx4 v[116:119], v3, s[24:27], 0 offen offset:704
  buffer_load_dwordx4 v[64:67], v5, s[4:7], 0 offen offset:768
  buffer_load_dwordx4 v[120:123], v3, s[24:27], 0 offen offset:768
  buffer_load_dwordx4 v[68:71], v5, s[4:7], 0 offen offset:832
  buffer_load_dwordx4 v[124:127], v3, s[24:27], 0 offen offset:832
  v_mov_b32 v12, 0
  v_mov_b32 v13, 0
  s_mov_b32 s43, 0xffff0000
  s_waitcnt vmcnt(27)
  v_lshlrev_b32 v200, 16, v16
  v_lshlrev_b32 v202, 16, v17
  v_lshlrev_b32 v204, 16, v18
  v_lshlrev_b32 v206, 16, v19
  v_and_b32 v16, s43, v16
  v_and_b32 v17, s43, v17
  v_and_b32 v18, s43, v18
  v_and_b32 v19, s43, v19
  s_waitcnt vmcnt(26)
  v_lshlrev_b32 v201, 16, v72
  v_lshlrev_b32 v203, 16, v73
  v_lshlrev_b32 v205, 16, v74
  v_lshlrev_b32 v207, 16, v75
  v_and_b32 v72, s43, v72
  v_and_b32 v73, s43, v73
  v_and_b32 v74, s43, v74
  v_and_b32 v75, s43, v75
  v_mul_f32 v200, v200, v201
  v_mul_f32 v202, v202, v203
  v_mul_f32 v204, v204, v205
  v_mul_f32 v206, v206, v207
  v_mul_f32 v16, v16, v72
  v_mul_f32 v17, v17, v73
  v_mul_f32 v18, v18, v74
  v_mul_f32 v19, v19, v75
  v_cvt_pk_bf16_f32 v200, v200, v16
  v_cvt_pk_bf16_f32 v202, v202, v17
  v_cvt_pk_bf16_f32 v204, v204, v18
  v_cvt_pk_bf16_f32 v206, v206, v19
  v_lshlrev_b32 v201, 16, v200
  v_lshlrev_b32 v203, 16, v202
  v_lshlrev_b32 v205, 16, v204
  v_lshlrev_b32 v207, 16, v206
  v_and_b32 v200, s43, v200
  v_and_b32 v202, s43, v202
  v_and_b32 v204, s43, v204
  v_and_b32 v206, s43, v206
  v_pk_add_f32 v[210:211], v[200:201], 0
  v_pk_add_f32 v[212:213], v[202:203], 0
  v_pk_add_f32 v[214:215], v[204:205], 0
  v_pk_add_f32 v[216:217], v[206:207], 0
  s_waitcnt vmcnt(25)
  v_lshlrev_b32 v200, 16, v20
  v_lshlrev_b32 v202, 16, v21
  v_lshlrev_b32 v204, 16, v22
  v_lshlrev_b32 v206, 16, v23
  v_and_b32 v20, s43, v20
  v_and_b32 v21, s43, v21
  v_and_b32 v22, s43, v22
  v_and_b32 v23, s43, v23
  s_waitcnt vmcnt(24)
  v_lshlrev_b32 v201, 16, v76
  v_lshlrev_b32 v203, 16, v77
  v_lshlrev_b32 v205, 16, v78
  v_lshlrev_b32 v207, 16, v79
  v_and_b32 v76, s43, v76
  v_and_b32 v77, s43, v77
  v_and_b32 v78, s43, v78
  v_and_b32 v79, s43, v79
  v_mul_f32 v200, v200, v201
  v_mul_f32 v202, v202, v203
  v_mul_f32 v204, v204, v205
  v_mul_f32 v206, v206, v207
  v_mul_f32 v20, v20, v76
  v_mul_f32 v21, v21, v77
  v_mul_f32 v22, v22, v78
  v_mul_f32 v23, v23, v79
  v_cvt_pk_bf16_f32 v200, v200, v20
  v_cvt_pk_bf16_f32 v202, v202, v21
  v_cvt_pk_bf16_f32 v204, v204, v22
  v_cvt_pk_bf16_f32 v206, v206, v23
  v_lshlrev_b32 v201, 16, v200
  v_lshlrev_b32 v203, 16, v202
  v_lshlrev_b32 v205, 16, v204
  v_lshlrev_b32 v207, 16, v206
  v_and_b32 v200, s43, v200
  v_and_b32 v202, s43, v202
  v_and_b32 v204, s43, v204
  v_and_b32 v206, s43, v206
  v_pk_add_f32 v[210:211], v[200:201], v[210:211]
  v_pk_add_f32 v[212:213], v[202:203], v[212:213]
  v_pk_add_f32 v[214:215], v[204:205], v[214:215]
  v_pk_add_f32 v[216:217], v[206:207], v[216:217]
  s_waitcnt vmcnt(23)
  v_lshlrev_b32 v200, 16, v24
  v_lshlrev_b32 v202, 16, v25
  v_lshlrev_b32 v204, 16, v26
  v_lshlrev_b32 v206, 16, v27
  v_and_b32 v24, s43, v24
  v_and_b32 v25, s43, v25
  v_and_b32 v26, s43, v26
  v_and_b32 v27, s43, v27
  s_waitcnt vmcnt(22)
  v_lshlrev_b32 v201, 16, v80
  v_lshlrev_b32 v203, 16, v81
  v_lshlrev_b32 v205, 16, v82
  v_lshlrev_b32 v207, 16, v83
  v_and_b32 v80, s43, v80
  v_and_b32 v81, s43, v81
  v_and_b32 v82, s43, v82
  v_and_b32 v83, s43, v83
  v_mul_f32 v200, v200, v201
  v_mul_f32 v202, v202, v203
  v_mul_f32 v204, v204, v205
  v_mul_f32 v206, v206, v207
  v_mul_f32 v24, v24, v80
  v_mul_f32 v25, v25, v81
  v_mul_f32 v26, v26, v82
  v_mul_f32 v27, v27, v83
  v_cvt_pk_bf16_f32 v200, v200, v24
  v_cvt_pk_bf16_f32 v202, v202, v25
  v_cvt_pk_bf16_f32 v204, v204, v26
  v_cvt_pk_bf16_f32 v206, v206, v27
  v_lshlrev_b32 v201, 16, v200
  v_lshlrev_b32 v203, 16, v202
  v_lshlrev_b32 v205, 16, v204
  v_lshlrev_b32 v207, 16, v206
  v_and_b32 v200, s43, v200
  v_and_b32 v202, s43, v202
  v_and_b32 v204, s43, v204
  v_and_b32 v206, s43, v206
  v_pk_add_f32 v[210:211], v[200:201], v[210:211]
  v_pk_add_f32 v[212:213], v[202:203], v[212:213]
  v_pk_add_f32 v[214:215], v[204:205], v[214:215]
  v_pk_add_f32 v[216:217], v[206:207], v[216:217]
  s_waitcnt vmcnt(21)
  v_lshlrev_b32 v200, 16, v28
  v_lshlrev_b32 v202, 16, v29
  v_lshlrev_b32 v204, 16, v30
  v_lshlrev_b32 v206, 16, v31
  v_and_b32 v28, s43, v28
  v_and_b32 v29, s43, v29
  v_and_b32 v30, s43, v30
  v_and_b32 v31, s43, v31
  s_waitcnt vmcnt(20)
  v_lshlrev_b32 v201, 16, v84
  v_lshlrev_b32 v203, 16, v85
  v_lshlrev_b32 v205, 16, v86
  v_lshlrev_b32 v207, 16, v87
  v_and_b32 v84, s43, v84
  v_and_b32 v85, s43, v85
  v_and_b32 v86, s43, v86
  v_and_b32 v87, s43, v87
  v_mul_f32 v200, v200, v201
  v_mul_f32 v202, v202, v203
  v_mul_f32 v204, v204, v205
  v_mul_f32 v206, v206, v207
  v_mul_f32 v28, v28, v84
  v_mul_f32 v29, v29, v85
  v_mul_f32 v30, v30, v86
  v_mul_f32 v31, v31, v87
  v_cvt_pk_bf16_f32 v200, v200, v28
  v_cvt_pk_bf16_f32 v202, v202, v29
  v_cvt_pk_bf16_f32 v204, v204, v30
  v_cvt_pk_bf16_f32 v206, v206, v31
  v_lshlrev_b32 v201, 16, v200
  v_lshlrev_b32 v203, 16, v202
  v_lshlrev_b32 v205, 16, v204
  v_lshlrev_b32 v207, 16, v206
  v_and_b32 v200, s43, v200
  v_and_b32 v202, s43, v202
  v_and_b32 v204, s43, v204
  v_and_b32 v206, s43, v206
  v_pk_add_f32 v[210:211], v[200:201], v[210:211]
  v_pk_add_f32 v[212:213], v[202:203], v[212:213]
  v_pk_add_f32 v[214:215], v[204:205], v[214:215]
  v_pk_add_f32 v[216:217], v[206:207], v[216:217]
  s_waitcnt vmcnt(19)
  v_lshlrev_b32 v200, 16, v32
  v_lshlrev_b32 v202, 16, v33
  v_lshlrev_b32 v204, 16, v34
  v_lshlrev_b32 v206, 16, v35
  v_and_b32 v32, s43, v32
  v_and_b32 v33, s43, v33
  v_and_b32 v34, s43, v34
  v_and_b32 v35, s43, v35
  s_waitcnt vmcnt(18)
  v_lshlrev_b32 v201, 16, v88
  v_lshlrev_b32 v203, 16, v89
  v_lshlrev_b32 v205, 16, v90
  v_lshlrev_b32 v207, 16, v91
  v_and_b32 v88, s43, v88
  v_and_b32 v89, s43, v89
  v_and_b32 v90, s43, v90
  v_and_b32 v91, s43, v91
  v_mul_f32 v200, v200, v201
  v_mul_f32 v202, v202, v203
  v_mul_f32 v204, v204, v205
  v_mul_f32 v206, v206, v207
  v_mul_f32 v32, v32, v88
  v_mul_f32 v33, v33, v89
  v_mul_f32 v34, v34, v90
  v_mul_f32 v35, v35, v91
  v_cvt_pk_bf16_f32 v200, v200, v32
  v_cvt_pk_bf16_f32 v202, v202, v33
  v_cvt_pk_bf16_f32 v204, v204, v34
  v_cvt_pk_bf16_f32 v206, v206, v35
  v_lshlrev_b32 v201, 16, v200
  v_lshlrev_b32 v203, 16, v202
  v_lshlrev_b32 v205, 16, v204
  v_lshlrev_b32 v207, 16, v206
  v_and_b32 v200, s43, v200
  v_and_b32 v202, s43, v202
  v_and_b32 v204, s43, v204
  v_and_b32 v206, s43, v206
  v_pk_add_f32 v[210:211], v[200:201], v[210:211]
  v_pk_add_f32 v[212:213], v[202:203], v[212:213]
  v_pk_add_f32 v[214:215], v[204:205], v[214:215]
  v_pk_add_f32 v[216:217], v[206:207], v[216:217]
  s_waitcnt vmcnt(17)
  v_lshlrev_b32 v200, 16, v36
  v_lshlrev_b32 v202, 16, v37
  v_lshlrev_b32 v204, 16, v38
  v_lshlrev_b32 v206, 16, v39
  v_and_b32 v36, s43, v36
  v_and_b32 v37, s43, v37
  v_and_b32 v38, s43, v38
  v_and_b32 v39, s43, v39
  s_waitcnt vmcnt(16)
  v_lshlrev_b32 v201, 16, v92
  v_lshlrev_b32 v203, 16, v93
  v_lshlrev_b32 v205, 16, v94
  v_lshlrev_b32 v207, 16, v95
  v_and_b32 v92, s43, v92
  v_and_b32 v93, s43, v93
  v_and_b32 v94, s43, v94
  v_and_b32 v95, s43, v95
  v_mul_f32 v200, v200, v201
  v_mul_f32 v202, v202, v203
  v_mul_f32 v204, v204, v205
  v_mul_f32 v206, v206, v207
  v_mul_f32 v36, v36, v92
  v_mul_f32 v37, v37, v93
  v_mul_f32 v38, v38, v94
  v_mul_f32 v39, v39, v95
  v_cvt_pk_bf16_f32 v200, v200, v36
  v_cvt_pk_bf16_f32 v202, v202, v37
  v_cvt_pk_bf16_f32 v204, v204, v38
  v_cvt_pk_bf16_f32 v206, v206, v39
  v_lshlrev_b32 v201, 16, v200
  v_lshlrev_b32 v203, 16, v202
  v_lshlrev_b32 v205, 16, v204
  v_lshlrev_b32 v207, 16, v206
  v_and_b32 v200, s43, v200
  v_and_b32 v202, s43, v202
  v_and_b32 v204, s43, v204
  v_and_b32 v206, s43, v206
  v_pk_add_f32 v[210:211], v[200:201], v[210:211]
  v_pk_add_f32 v[212:213], v[202:203], v[212:213]
  v_pk_add_f32 v[214:215], v[204:205], v[214:215]
  v_pk_add_f32 v[216:217], v[206:207], v[216:217]
  s_waitcnt vmcnt(15)
  v_lshlrev_b32 v200, 16, v40
  v_lshlrev_b32 v202, 16, v41
  v_lshlrev_b32 v204, 16, v42
  v_lshlrev_b32 v206, 16, v43
  v_and_b32 v40, s43, v40
  v_and_b32 v41, s43, v41
  v_and_b32 v42, s43, v42
  v_and_b32 v43, s43, v43
  s_waitcnt vmcnt(14)
  v_lshlrev_b32 v201, 16, v96
  v_lshlrev_b32 v203, 16, v97
  v_lshlrev_b32 v205, 16, v98
  v_lshlrev_b32 v207, 16, v99
  v_and_b32 v96, s43, v96
  v_and_b32 v97, s43, v97
  v_and_b32 v98, s43, v98
  v_and_b32 v99, s43, v99
  v_mul_f32 v200, v200, v201
  v_mul_f32 v202, v202, v203
  v_mul_f32 v204, v204, v205
  v_mul_f32 v206, v206, v207
  v_mul_f32 v40, v40, v96
  v_mul_f32 v41, v41, v97
  v_mul_f32 v42, v42, v98
  v_mul_f32 v43, v43, v99
  v_cvt_pk_bf16_f32 v200, v200, v40
  v_cvt_pk_bf16_f32 v202, v202, v41
  v_cvt_pk_bf16_f32 v204, v204, v42
  v_cvt_pk_bf16_f32 v206, v206, v43
  v_lshlrev_b32 v201, 16, v200
  v_lshlrev_b32 v203, 16, v202
  v_lshlrev_b32 v205, 16, v204
  v_lshlrev_b32 v207, 16, v206
  v_and_b32 v200, s43, v200
  v_and_b32 v202, s43, v202
  v_and_b32 v204, s43, v204
  v_and_b32 v206, s43, v206
  v_pk_add_f32 v[210:211], v[200:201], v[210:211]
  v_pk_add_f32 v[212:213], v[202:203], v[212:213]
  v_pk_add_f32 v[214:215], v[204:205], v[214:215]
  v_pk_add_f32 v[216:217], v[206:207], v[216:217]
  s_waitcnt vmcnt(13)
  v_lshlrev_b32 v200, 16, v44
  v_lshlrev_b32 v202, 16, v45
  v_lshlrev_b32 v204, 16, v46
  v_lshlrev_b32 v206, 16, v47
  v_and_b32 v44, s43, v44
  v_and_b32 v45, s43, v45
  v_and_b32 v46, s43, v46
  v_and_b32 v47, s43, v47
  s_waitcnt vmcnt(12)
  v_lshlrev_b32 v201, 16, v100
  v_lshlrev_b32 v203, 16, v101
  v_lshlrev_b32 v205, 16, v102
  v_lshlrev_b32 v207, 16, v103
  v_and_b32 v100, s43, v100
  v_and_b32 v101, s43, v101
  v_and_b32 v102, s43, v102
  v_and_b32 v103, s43, v103
  v_mul_f32 v200, v200, v201
  v_mul_f32 v202, v202, v203
  v_mul_f32 v204, v204, v205
  v_mul_f32 v206, v206, v207
  v_mul_f32 v44, v44, v100
  v_mul_f32 v45, v45, v101
  v_mul_f32 v46, v46, v102
  v_mul_f32 v47, v47, v103
  v_cvt_pk_bf16_f32 v200, v200, v44
  v_cvt_pk_bf16_f32 v202, v202, v45
  v_cvt_pk_bf16_f32 v204, v204, v46
  v_cvt_pk_bf16_f32 v206, v206, v47
  v_lshlrev_b32 v201, 16, v200
  v_lshlrev_b32 v203, 16, v202
  v_lshlrev_b32 v205, 16, v204
  v_lshlrev_b32 v207, 16, v206
  v_and_b32 v200, s43, v200
  v_and_b32 v202, s43, v202
  v_and_b32 v204, s43, v204
  v_and_b32 v206, s43, v206
  v_pk_add_f32 v[210:211], v[200:201], v[210:211]
  v_pk_add_f32 v[212:213], v[202:203], v[212:213]
  v_pk_add_f32 v[214:215], v[204:205], v[214:215]
  v_pk_add_f32 v[216:217], v[206:207], v[216:217]
  s_waitcnt vmcnt(11)
  v_lshlrev_b32 v200, 16, v48
  v_lshlrev_b32 v202, 16, v49
  v_lshlrev_b32 v204, 16, v50
  v_lshlrev_b32 v206, 16, v51
  v_and_b32 v48, s43, v48
  v_and_b32 v49, s43, v49
  v_and_b32 v50, s43, v50
  v_and_b32 v51, s43, v51
  s_waitcnt vmcnt(10)
  v_lshlrev_b32 v201, 16, v104
  v_lshlrev_b32 v203, 16, v105
  v_lshlrev_b32 v205, 16, v106
  v_lshlrev_b32 v207, 16, v107
  v_and_b32 v104, s43, v104
  v_and_b32 v105, s43, v105
  v_and_b32 v106, s43, v106
  v_and_b32 v107, s43, v107
  v_mul_f32 v200, v200, v201
  v_mul_f32 v202, v202, v203
  v_mul_f32 v204, v204, v205
  v_mul_f32 v206, v206, v207
  v_mul_f32 v48, v48, v104
  v_mul_f32 v49, v49, v105
  v_mul_f32 v50, v50, v106
  v_mul_f32 v51, v51, v107
  v_cvt_pk_bf16_f32 v200, v200, v48
  v_cvt_pk_bf16_f32 v202, v202, v49
  v_cvt_pk_bf16_f32 v204, v204, v50
  v_cvt_pk_bf16_f32 v206, v206, v51
  v_lshlrev_b32 v201, 16, v200
  v_lshlrev_b32 v203, 16, v202
  v_lshlrev_b32 v205, 16, v204
  v_lshlrev_b32 v207, 16, v206
  v_and_b32 v200, s43, v200
  v_and_b32 v202, s43, v202
  v_and_b32 v204, s43, v204
  v_and_b32 v206, s43, v206
  v_pk_add_f32 v[210:211], v[200:201], v[210:211]
  v_pk_add_f32 v[212:213], v[202:203], v[212:213]
  v_pk_add_f32 v[214:215], v[204:205], v[214:215]
  v_pk_add_f32 v[216:217], v[206:207], v[216:217]
  s_waitcnt vmcnt(9)
  v_lshlrev_b32 v200, 16, v52
  v_lshlrev_b32 v202, 16, v53
  v_lshlrev_b32 v204, 16, v54
  v_lshlrev_b32 v206, 16, v55
  v_and_b32 v52, s43, v52
  v_and_b32 v53, s43, v53
  v_and_b32 v54, s43, v54
  v_and_b32 v55, s43, v55
  s_waitcnt vmcnt(8)
  v_lshlrev_b32 v201, 16, v108
  v_lshlrev_b32 v203, 16, v109
  v_lshlrev_b32 v205, 16, v110
  v_lshlrev_b32 v207, 16, v111
  v_and_b32 v108, s43, v108
  v_and_b32 v109, s43, v109
  v_and_b32 v110, s43, v110
  v_and_b32 v111, s43, v111
  v_mul_f32 v200, v200, v201
  v_mul_f32 v202, v202, v203
  v_mul_f32 v204, v204, v205
  v_mul_f32 v206, v206, v207
  v_mul_f32 v52, v52, v108
  v_mul_f32 v53, v53, v109
  v_mul_f32 v54, v54, v110
  v_mul_f32 v55, v55, v111
  v_cvt_pk_bf16_f32 v200, v200, v52
  v_cvt_pk_bf16_f32 v202, v202, v53
  v_cvt_pk_bf16_f32 v204, v204, v54
  v_cvt_pk_bf16_f32 v206, v206, v55
  v_lshlrev_b32 v201, 16, v200
  v_lshlrev_b32 v203, 16, v202
  v_lshlrev_b32 v205, 16, v204
  v_lshlrev_b32 v207, 16, v206
  v_and_b32 v200, s43, v200
  v_and_b32 v202, s43, v202
  v_and_b32 v204, s43, v204
  v_and_b32 v206, s43, v206
  v_pk_add_f32 v[210:211], v[200:201], v[210:211]
  v_pk_add_f32 v[212:213], v[202:203], v[212:213]
  v_pk_add_f32 v[214:215], v[204:205], v[214:215]
  v_pk_add_f32 v[216:217], v[206:207], v[216:217]
  s_waitcnt vmcnt(7)
  v_lshlrev_b32 v200, 16, v56
  v_lshlrev_b32 v202, 16, v57
  v_lshlrev_b32 v204, 16, v58
  v_lshlrev_b32 v206, 16, v59
  v_and_b32 v56, s43, v56
  v_and_b32 v57, s43, v57
  v_and_b32 v58, s43, v58
  v_and_b32 v59, s43, v59
  s_waitcnt vmcnt(6)
  v_lshlrev_b32 v201, 16, v112
  v_lshlrev_b32 v203, 16, v113
  v_lshlrev_b32 v205, 16, v114
  v_lshlrev_b32 v207, 16, v115
  v_and_b32 v112, s43, v112
  v_and_b32 v113, s43, v113
  v_and_b32 v114, s43, v114
  v_and_b32 v115, s43, v115
  v_mul_f32 v200, v200, v201
  v_mul_f32 v202, v202, v203
  v_mul_f32 v204, v204, v205
  v_mul_f32 v206, v206, v207
  v_mul_f32 v56, v56, v112
  v_mul_f32 v57, v57, v113
  v_mul_f32 v58, v58, v114
  v_mul_f32 v59, v59, v115
  v_cvt_pk_bf16_f32 v200, v200, v56
  v_cvt_pk_bf16_f32 v202, v202, v57
  v_cvt_pk_bf16_f32 v204, v204, v58
  v_cvt_pk_bf16_f32 v206, v206, v59
  v_lshlrev_b32 v201, 16, v200
  v_lshlrev_b32 v203, 16, v202
  v_lshlrev_b32 v205, 16, v204
  v_lshlrev_b32 v207, 16, v206
  v_and_b32 v200, s43, v200
  v_and_b32 v202, s43, v202
  v_and_b32 v204, s43, v204
  v_and_b32 v206, s43, v206
  v_pk_add_f32 v[210:211], v[200:201], v[210:211]
  v_pk_add_f32 v[212:213], v[202:203], v[212:213]
  v_pk_add_f32 v[214:215], v[204:205], v[214:215]
  v_pk_add_f32 v[216:217], v[206:207], v[216:217]
  s_waitcnt vmcnt(5)
  v_lshlrev_b32 v200, 16, v60
  v_lshlrev_b32 v202, 16, v61
  v_lshlrev_b32 v204, 16, v62
  v_lshlrev_b32 v206, 16, v63
  v_and_b32 v60, s43, v60
  v_and_b32 v61, s43, v61
  v_and_b32 v62, s43, v62
  v_and_b32 v63, s43, v63
  s_waitcnt vmcnt(4)
  v_lshlrev_b32 v201, 16, v116
  v_lshlrev_b32 v203, 16, v117
  v_lshlrev_b32 v205, 16, v118
  v_lshlrev_b32 v207, 16, v119
  v_and_b32 v116, s43, v116
  v_and_b32 v117, s43, v117
  v_and_b32 v118, s43, v118
  v_and_b32 v119, s43, v119
  v_mul_f32 v200, v200, v201
  v_mul_f32 v202, v202, v203
  v_mul_f32 v204, v204, v205
  v_mul_f32 v206, v206, v207
  v_mul_f32 v60, v60, v116
  v_mul_f32 v61, v61, v117
  v_mul_f32 v62, v62, v118
  v_mul_f32 v63, v63, v119
  v_cvt_pk_bf16_f32 v200, v200, v60
  v_cvt_pk_bf16_f32 v202, v202, v61
  v_cvt_pk_bf16_f32 v204, v204, v62
  v_cvt_pk_bf16_f32 v206, v206, v63
  v_lshlrev_b32 v201, 16, v200
  v_lshlrev_b32 v203, 16, v202
  v_lshlrev_b32 v205, 16, v204
  v_lshlrev_b32 v207, 16, v206
  v_and_b32 v200, s43, v200
  v_and_b32 v202, s43, v202
  v_and_b32 v204, s43, v204
  v_and_b32 v206, s43, v206
  v_pk_add_f32 v[210:211], v[200:201], v[210:211]
  v_pk_add_f32 v[212:213], v[202:203], v[212:213]
  v_pk_add_f32 v[214:215], v[204:205], v[214:215]
  v_pk_add_f32 v[216:217], v[206:207], v[216:217]
  s_waitcnt vmcnt(3)
  v_lshlrev_b32 v200, 16, v64
  v_lshlrev_b32 v202, 16, v65
  v_lshlrev_b32 v204, 16, v66
  v_lshlrev_b32 v206, 16, v67
  v_and_b32 v64, s43, v64
  v_and_b32 v65, s43, v65
  v_and_b32 v66, s43, v66
  v_and_b32 v67, s43, v67
  s_waitcnt vmcnt(2)
  v_lshlrev_b32 v201, 16, v120
  v_lshlrev_b32 v203, 16, v121
  v_lshlrev_b32 v205, 16, v122
  v_lshlrev_b32 v207, 16, v123
  v_and_b32 v120, s43, v120
  v_and_b32 v121, s43, v121
  v_and_b32 v122, s43, v122
  v_and_b32 v123, s43, v123
  v_mul_f32 v200, v200, v201
  v_mul_f32 v202, v202, v203
  v_mul_f32 v204, v204, v205
  v_mul_f32 v206, v206, v207
  v_mul_f32 v64, v64, v120
  v_mul_f32 v65, v65, v121
  v_mul_f32 v66, v66, v122
  v_mul_f32 v67, v67, v123
  v_cvt_pk_bf16_f32 v200, v200, v64
  v_cvt_pk_bf16_f32 v202, v202, v65
  v_cvt_pk_bf16_f32 v204, v204, v66
  v_cvt_pk_bf16_f32 v206, v206, v67
  v_lshlrev_b32 v201, 16, v200
  v_lshlrev_b32 v203, 16, v202
  v_lshlrev_b32 v205, 16, v204
  v_lshlrev_b32 v207, 16, v206
  v_and_b32 v200, s43, v200
  v_and_b32 v202, s43, v202
  v_and_b32 v204, s43, v204
  v_and_b32 v206, s43, v206
  v_pk_add_f32 v[210:211], v[200:201], v[210:211]
  v_pk_add_f32 v[212:213], v[202:203], v[212:213]
  v_pk_add_f32 v[214:215], v[204:205], v[214:215]
  v_pk_add_f32 v[216:217], v[206:207], v[216:217]
  s_waitcnt vmcnt(1)
  v_lshlrev_b32 v200, 16, v68
  v_lshlrev_b32 v202, 16, v69
  v_lshlrev_b32 v204, 16, v70
  v_lshlrev_b32 v206, 16, v71
  v_and_b32 v68, s43, v68
  v_and_b32 v69, s43, v69
  v_and_b32 v70, s43, v70
  v_and_b32 v71, s43, v71
  s_waitcnt vmcnt(0)
  v_lshlrev_b32 v201, 16, v124
  v_lshlrev_b32 v203, 16, v125
  v_lshlrev_b32 v205, 16, v126
  v_lshlrev_b32 v207, 16, v127
  v_and_b32 v124, s43, v124
  v_and_b32 v125, s43, v125
  v_and_b32 v126, s43, v126
  v_and_b32 v127, s43, v127
  v_mul_f32 v200, v200, v201
  v_mul_f32 v202, v202, v203
  v_mul_f32 v204, v204, v205
  v_mul_f32 v206, v206, v207
  v_mul_f32 v68, v68, v124
  v_mul_f32 v69, v69, v125
  v_mul_f32 v70, v70, v126
  v_mul_f32 v71, v71, v127
  v_cvt_pk_bf16_f32 v200, v200, v68
  v_cvt_pk_bf16_f32 v202, v202, v69
  v_cvt_pk_bf16_f32 v204, v204, v70
  v_cvt_pk_bf16_f32 v206, v206, v71
  v_lshlrev_b32 v201, 16, v200
  v_lshlrev_b32 v203, 16, v202
  v_lshlrev_b32 v205, 16, v204
  v_lshlrev_b32 v207, 16, v206
  v_and_b32 v200, s43, v200
  v_and_b32 v202, s43, v202
  v_and_b32 v204, s43, v204
  v_and_b32 v206, s43, v206
  v_pk_add_f32 v[210:211], v[200:201], v[210:211]
  v_pk_add_f32 v[212:213], v[202:203], v[212:213]
  v_pk_add_f32 v[214:215], v[204:205], v[214:215]
  v_pk_add_f32 v[216:217], v[206:207], v[216:217]
  v_pk_add_f32 v[210:211], v[210:211], v[212:213]
  v_pk_add_f32 v[214:215], v[214:215], v[216:217]
  v_pk_add_f32 v[12:13], v[210:211], v[214:215]
  v_add_f32 v12, v12, v13
  s_nop 1
  v_add_f32_dpp v12, v12, v12 quad_perm:[1,0,3,2] row_mask:0xf bank_mask:0xf
  s_nop 1
  v_add_f32_dpp v12, v12, v12 quad_perm:[2,3,0,1] row_mask:0xf bank_mask:0xf
  v_cvt_pk_bf16_f32 v12, v12, v12
  v_lshlrev_b32 v12, 16, v12
  v_mul_f32 v12, 0xbfb8aa3b, v12
  v_exp_f32 v12, v12
  s_nop 0
  v_add_f32 v12, 1.0, v12
  v_rcp_f32 v12, v12
  s_nop 0
  v_cvt_pk_bf16_f32 v12, v12, v12
  v_lshlrev_b32 v12, 16, v12
  v_sub_f32 v13, 1.0, v12
  v_cvt_pk_bf16_f32 v13, v13, v13
  v_lshlrev_b32 v13, 16, v13
  v_cmp_eq_u32 vcc, 0, v2
  v_lshlrev_b32 v4, 3, v4
  v_add_u32 v4, 13418496, v4
  v_cndmask_b32 v4, v6, v4, vcc
  buffer_store_dwordx2 v[12:13], v4, s[20:23], 0 offen sc1
  s_waitcnt vmcnt(0)
  s_barrier
  buffer_store_dword v9, v8, s[20:23], 0 offen offset:1024 sc0 sc1
  s_endpgm
L1_end:
  s_endpgm

.section .rodata,"a"
.p2align 6
.amdhsa_kernel gated_mix__ssm_conv_s5__glu_gated_geglu__prompt_kernel
  .amdhsa_next_free_vgpr 512
  .amdhsa_next_free_sgpr 102
  .amdhsa_accum_offset 256
  .amdhsa_group_segment_fixed_size 0
  .amdhsa_kernarg_size 136
  .amdhsa_user_sgpr_count 2
  .amdhsa_user_sgpr_kernarg_segment_ptr 1
  .amdhsa_system_sgpr_workgroup_id_x 1
.end_amdhsa_kernel
```
